```python
import torch

def _softmax(x, axis=-1):
    return torch.softmax(x, dim=axis)

def _gelu(x):
    return torch.nn.functional.gelu(x, approximate='tanh')

def _silu(x):
    return torch.nn.functional.silu(x)

def _sigmoid(x):
    return torch.sigmoid(x)

def _layernorm(x, axis=-1, eps=1e-05):
    m = x.mean(dim=axis, keepdim=True)
    v = x.var(dim=axis, keepdim=True, unbiased=False)
    return (x - m) / torch.sqrt(v + eps)

def _scatter_add(tgt, idx, src, axis=0):
    return tgt.clone().index_add_(axis, idx, src)

def _segment_sum(src, seg, n):
    out = torch.zeros((n,) + src.shape[1:], dtype=src.dtype)
    return out.index_add_(0, seg, src)

def _pad(x, pw):
    flat = tuple((v for pair in reversed(pw) for v in pair))
    return torch.nn.functional.pad(x, flat)
kernel_name = 'standalone__dit_adaln_block__diffusion'

def setup_inputs():

    _w = lambda a: (lambda t: t.to(torch.bfloat16) if t.is_floating_point() else t)(torch.as_tensor(a))
    B, N, D = (2, 1024, 384)
    return {'x': _w((lambda *s: torch.randn(*s, dtype=torch.bfloat16) * 0.05)(B, N, D)), 'c': _w((lambda *s: torch.randn(*s, dtype=torch.bfloat16) * 0.2)(B, D)), 'wqkv': _w((lambda *s: torch.randn(*s, dtype=torch.bfloat16) * 0.05)(D, 3 * D)), 'wo': _w((lambda *s: torch.randn(*s, dtype=torch.bfloat16) * 0.1)(D, D)), 'w_mod': _w((lambda *s: torch.randn(*s, dtype=torch.bfloat16) * 0.2)(D, 6 * D))}

def reference(x, c, wqkv, wo, w_mod):
    B, N, D = x.shape
    mod = (_silu(c) @ w_mod).reshape(B, 6, 1, D)
    shift_a, scale_a, gate_a, shift_m, scale_m, gate_m = [mod[:, i] for i in range(6)]
    h = _layernorm(x, axis=-1) * (1 + scale_a) + shift_a
    qkv = h @ wqkv
    q, k, v = (qkv[..., :D].clone(), qkv[..., D:2 * D].clone(), qkv[..., 2 * D:].clone())
    p = _softmax(torch.einsum('bqd,bkd->bqk', q, k) * D ** (-0.5), axis=-1)
    a = torch.einsum('bqk,bkd->bqd', p, v) @ wo
    return x + gate_a * a
```

```asm
; @launch grid=(256,1,1) block=(256,1,1) lds=76032
.amdgcn_target "amdgcn-amd-amdhsa--gfx950"
.text
.globl standalone__dit_adaln_block__diffusion_kernel
.p2align 8
.type standalone__dit_adaln_block__diffusion_kernel,@function
standalone__dit_adaln_block__diffusion_kernel:
    s_cmp_ge_u32 s2, 256
    s_cbranch_scc1 F_END
    s_load_dwordx16 s[16:31], s[0:1], 0
    s_memrealtime s[68:69]
    s_lshr_b32 s12, s2, 3
    s_cmp_lg_u32 s12, 0
    s_cbranch_scc1 CPF_DONE
    s_getpc_b64 s[12:13]
CPF_PC:
    s_sub_u32 s12, s12, CPF_PC-standalone__dit_adaln_block__diffusion_kernel
    s_subb_u32 s13, s13, 0
    v_lshlrev_b32 v16, 7, v0
    v_min_u32 v16, F_CODE_END-standalone__dit_adaln_block__diffusion_kernel-4, v16
    global_load_dword v255, v16, s[12:13]
CPF_DONE:
    v_and_b32 v1, 63, v0
    v_lshrrev_b32 v2, 6, v0
    v_lshlrev_b32 v5, 4, v1
    v_readfirstlane_b32 s3, v2
    v_bfe_u32 v4, v0, 5, 1
    v_lshlrev_b32 v6, 4, v0
    v_and_b32 v3, 15, v1
    s_and_b32 s60, s2, 7
    s_lshr_b32 s61, s2, 3
    s_lshl_b32 s4, s60, 2
    s_and_b32 s6, s61, 3
    s_add_u32 s4, s4, s6
    s_lshr_b32 s5, s61, 2
    s_lshr_b32 s6, s60, 2
    s_and_b32 s62, s60, 1
    s_lshl_b32 s62, s62, 3
    s_and_b32 s12, s61, 7
    s_add_u32 s62, s62, s12
    s_lshl_b32 s13, s6, 4
    s_add_u32 s62, s62, s13
    s_bfe_u32 s63, s60, 0x10001
    s_lshl_b32 s63, s63, 2
    s_lshr_b32 s65, s61, 3
    s_add_u32 s63, s63, s65
    s_lshl_b32 s64, s60, 3
    s_add_u32 s64, s64, s12
    s_lshl_b32 s66, s63, 2
    s_add_u32 s66, s66, s3
    s_lshl_b32 s67, s6, 5
    s_add_u32 s67, s67, s66
    s_mul_i32 s67, s67, 24576
    s_add_u32 s67, s67, 1048576
    v_lshrrev_b32 v9, 4, v1
    v_mul_u32_u24 v10, 768, v9
    v_lshl_add_u32 v10, v3, 4, v10
    v_and_b32 v7, 7, v3
    v_xor_b32 v7, v7, v9
    v_lshlrev_b32 v8, 9, v3
    v_lshl_add_u32 v8, v7, 4, v8
    s_lshr_b32 s12, s3, 1
    s_mul_i32 s12, s12, 24576
    s_and_b32 s13, s3, 1
    s_lshl_b32 s13, s13, 8
    s_add_u32 s12, s12, s13
    v_add_u32 v8, s12, v8
    v_xor_b32 v2, 64, v8
    v_lshlrev_b32 v7, 5, v3
    s_lshl_b32 s7, s4, 6
    s_lshl_b32 s12, s3, 4
    s_add_u32 s7, s7, s12
    s_mul_i32 s7, s7, 768
    v_and_b32 v11, 31, v1
    v_xor_b32 v11, v11, v4
    v_lshlrev_b32 v11, 4, v11
    v_lshl_add_u32 v240, v4, 9, v11
    v_xor_b32 v241, 32, v240
    v_xor_b32 v242, 64, v240
    v_xor_b32 v243, 96, v240
    v_lshrrev_b32 v11, 3, v1
    v_and_b32 v12, 7, v1
    v_mul_u32_u24 v13, 2304, v11
    v_lshl_add_u32 v13, v12, 4, v13
    s_cmp_ge_u32 s61, 9
    s_cselect_b32 s59, 1, 0
    s_mul_i32 s12, s59, 9
    s_sub_u32 s12, s61, s12
    s_mul_i32 s13, s12, 86
    s_lshr_b32 s13, s13, 8
    s_mul_i32 s14, s13, 3
    s_sub_u32 s14, s12, s14
    s_lshr_b32 s12, s60, 1
    s_mul_i32 s12, s12, 3
    s_add_u32 s8, s12, s13
    s_and_b32 s12, s60, 1
    s_mul_i32 s12, s12, 3
    s_add_u32 s9, s12, s14
    s_lshl_b32 s10, s8, 5
    s_lshl_b32 s12, s3, 3
    s_add_u32 s10, s10, s12
    s_mul_i32 s10, s10, 2304
    s_mul_i32 s12, s59, 1536
    s_add_u32 s10, s10, s12
    s_mul_i32 s11, s3, 1056
    s_add_u32 s11, s11, 0
    s_waitcnt lgkmcnt(0)
    s_mov_b32 s32, s20
    s_and_b32 s33, s21, 0xffff
    s_mov_b32 s34, 884736
    s_mov_b32 s35, 0x20000
    s_cmp_ge_u32 s61, 18
    s_cbranch_scc1 P1_NOA
    s_add_u32 m0, s11, 0
    s_nop 0
    buffer_load_dwordx4 v13, s[32:35], s10 offen lds
    s_add_u32 s10, s10, 128
    s_add_u32 m0, s11, 4224
    s_nop 0
    buffer_load_dwordx4 v13, s[32:35], s10 offen lds
    s_add_u32 s10, s10, 128
    s_add_u32 m0, s11, 8448
    s_nop 0
    buffer_load_dwordx4 v13, s[32:35], s10 offen lds
    s_add_u32 s10, s10, 128
    s_add_u32 m0, s11, 12672
    s_nop 0
    buffer_load_dwordx4 v13, s[32:35], s10 offen lds
    s_add_u32 s10, s10, 128
    s_add_u32 m0, s11, 16896
    s_nop 0
    buffer_load_dwordx4 v13, s[32:35], s10 offen lds
    s_add_u32 s10, s10, 128
    s_add_u32 m0, s11, 21120
    s_nop 0
    buffer_load_dwordx4 v13, s[32:35], s10 offen lds
P1_NOA:
    s_mov_b32 s40, s30
    s_and_b32 s41, s31, 0xffff
    s_mov_b32 s42, 20971520
    s_mov_b32 s43, 0x20000
    s_mov_b32 s52, s28
    s_and_b32 s53, s29, 0xffff
    s_mov_b32 s54, 256
    s_mov_b32 s55, 0x20000
    s_mov_b32 s44, s16
    s_and_b32 s45, s17, 0xffff
    s_mov_b32 s46, 1572864
    s_mov_b32 s47, 0x20000
    v_mov_b32 v15, 0
    s_mov_b32 s70, 0
    s_cmp_lg_u32 s3, 0
    s_cbranch_scc1 N_DONE
    s_cmp_lg_u32 s2, 0
    s_cbranch_scc1 N_DONE
    s_or_b32 s68, s68, 1
    s_mov_b32 s70, 1
    v_mov_b32 v16, s68
    v_mov_b32 v17, s69
    s_mov_b64 exec, 1
    buffer_store_dwordx2 v[16:17], v15, s[52:55], 0 offen sc0 sc1
    s_mov_b64 exec, -1
    s_nop 1
N_DONE:
    s_cmp_ge_u32 s61, 21
    s_cbranch_scc1 P1_IDLE
    s_cmp_ge_u32 s61, 18
    s_cbranch_scc1 P1_MOD
    s_cmp_eq_u32 s59, 1
    s_cbranch_scc1 P1_VO
    s_lshl_b32 s10, s9, 6
    s_lshl_b32 s12, s3, 4
    s_add_u32 s10, s10, s12
    s_mul_i32 s10, s10, 2304
    s_add_u32 s10, s10, 768
    s_add_u32 s12, s10, 18432
    s_mul_i32 s11, s3, 2112
    s_add_u32 s11, s11, 25344
    s_add_u32 m0, s11, 0
    s_nop 0
    buffer_load_dwordx4 v13, s[32:35], s10 offen lds
    s_add_u32 m0, s11, 1056
    s_nop 0
    buffer_load_dwordx4 v13, s[32:35], s12 offen lds
    s_add_u32 s10, s10, 128
    s_add_u32 s12, s12, 128
    s_add_u32 m0, s11, 8448
    s_nop 0
    buffer_load_dwordx4 v13, s[32:35], s10 offen lds
    s_add_u32 m0, s11, 9504
    s_nop 0
    buffer_load_dwordx4 v13, s[32:35], s12 offen lds
    s_add_u32 s10, s10, 128
    s_add_u32 s12, s12, 128
    s_add_u32 m0, s11, 16896
    s_nop 0
    buffer_load_dwordx4 v13, s[32:35], s10 offen lds
    s_add_u32 m0, s11, 17952
    s_nop 0
    buffer_load_dwordx4 v13, s[32:35], s12 offen lds
    s_add_u32 s10, s10, 128
    s_add_u32 s12, s12, 128
    s_add_u32 m0, s11, 25344
    s_nop 0
    buffer_load_dwordx4 v13, s[32:35], s10 offen lds
    s_add_u32 m0, s11, 26400
    s_nop 0
    buffer_load_dwordx4 v13, s[32:35], s12 offen lds
    s_add_u32 s10, s10, 128
    s_add_u32 s12, s12, 128
    s_add_u32 m0, s11, 33792
    s_nop 0
    buffer_load_dwordx4 v13, s[32:35], s10 offen lds
    s_add_u32 m0, s11, 34848
    s_nop 0
    buffer_load_dwordx4 v13, s[32:35], s12 offen lds
    s_add_u32 s10, s10, 128
    s_add_u32 s12, s12, 128
    s_add_u32 m0, s11, 42240
    s_nop 0
    buffer_load_dwordx4 v13, s[32:35], s10 offen lds
    s_add_u32 m0, s11, 43296
    s_nop 0
    buffer_load_dwordx4 v13, s[32:35], s12 offen lds
    s_mov_b32 s57, 0
    s_branch P1_GO
P1_MOD:
    s_sub_u32 s9, s61, 18
    s_lshl_b32 s9, s9, 3
    s_add_u32 s9, s9, s60
    s_cmp_ge_u32 s9, 18
    s_cbranch_scc1 P1_IDLE
    s_mov_b32 s59, 2
    s_mov_b32 s8, 0
    s_mov_b32 s36, s24
    s_and_b32 s37, s25, 0xffff
    s_mov_b32 s38, 1769472
    s_mov_b32 s39, 0x20000
    s_mov_b32 s48, s18
    s_and_b32 s49, s19, 0xffff
    s_mov_b32 s50, 1536
    s_mov_b32 s51, 0x20000
    s_mov_b32 s13, 4608
    v_lshlrev_b32 v14, 2, v0
    buffer_load_dword v16, v14, s[48:51], 0 offen
    buffer_load_dword v17, v14, s[48:51], 0 offen offset:768
    s_branch P1_TRB
P1_VO:
    s_mov_b32 s36, s22
    s_and_b32 s37, s23, 0xffff
    s_mov_b32 s38, 294912
    s_mov_b32 s39, 0x20000
    s_mov_b32 s13, 768
P1_TRB:
    v_and_b32 v18, 1, v11
    v_bfe_u32 v19, v11, 1, 1
    v_lshl_add_u32 v18, v19, 2, v18
    v_lshrrev_b32 v19, 2, v11
    v_lshl_add_u32 v18, v19, 4, v18
    v_mul_u32_u24 v18, s13, v18
    v_lshl_add_u32 v21, v12, 4, v18
    s_mul_i32 s10, s3, 96
    s_mul_i32 s10, s10, s13
    s_lshl_b32 s12, s9, 7
    s_add_u32 s10, s10, s12
    s_lshl_b32 s12, s13, 1
    s_mul_i32 s71, s13, 6
    s_mul_i32 s14, s13, 22
    s_mul_i32 s11, s3, 12672
    s_add_u32 s11, s11, 25344
    s_add_u32 m0, s11, 0
    s_nop 0
    buffer_load_dwordx4 v21, s[36:39], s10 offen lds
    s_add_u32 s10, s10, s12
    s_add_u32 m0, s11, 1056
    s_nop 0
    buffer_load_dwordx4 v21, s[36:39], s10 offen lds
    s_add_u32 s10, s10, s71
    s_add_u32 m0, s11, 2112
    s_nop 0
    buffer_load_dwordx4 v21, s[36:39], s10 offen lds
    s_add_u32 s10, s10, s12
    s_add_u32 m0, s11, 3168
    s_nop 0
    buffer_load_dwordx4 v21, s[36:39], s10 offen lds
    s_add_u32 s10, s10, s14
    s_add_u32 m0, s11, 4224
    s_nop 0
    buffer_load_dwordx4 v21, s[36:39], s10 offen lds
    s_add_u32 s10, s10, s12
    s_add_u32 m0, s11, 5280
    s_nop 0
    buffer_load_dwordx4 v21, s[36:39], s10 offen lds
    s_add_u32 s10, s10, s71
    s_add_u32 m0, s11, 6336
    s_nop 0
    buffer_load_dwordx4 v21, s[36:39], s10 offen lds
    s_add_u32 s10, s10, s12
    s_add_u32 m0, s11, 7392
    s_nop 0
    buffer_load_dwordx4 v21, s[36:39], s10 offen lds
    s_add_u32 s10, s10, s14
    s_add_u32 m0, s11, 8448
    s_nop 0
    buffer_load_dwordx4 v21, s[36:39], s10 offen lds
    s_add_u32 s10, s10, s12
    s_add_u32 m0, s11, 9504
    s_nop 0
    buffer_load_dwordx4 v21, s[36:39], s10 offen lds
    s_add_u32 s10, s10, s71
    s_add_u32 m0, s11, 10560
    s_nop 0
    buffer_load_dwordx4 v21, s[36:39], s10 offen lds
    s_add_u32 s10, s10, s12
    s_add_u32 m0, s11, 11616
    s_nop 0
    buffer_load_dwordx4 v21, s[36:39], s10 offen lds
    s_mov_b32 s57, 1
    s_cmp_lg_u32 s59, 2
    s_cbranch_scc1 P1_GO
    s_waitcnt vmcnt(12)
    v_lshlrev_b32 v24, 16, v16
    v_and_b32 v25, 0xffff0000, v16
    v_lshlrev_b32 v26, 16, v17
    v_and_b32 v27, 0xffff0000, v17
    s_mov_b32 s12, 0xbfb8aa3b
    v_mul_f32 v28, s12, v24
    v_mul_f32 v29, s12, v25
    v_mul_f32 v30, s12, v26
    v_mul_f32 v31, s12, v27
    v_exp_f32 v28, v28
    v_exp_f32 v29, v29
    v_exp_f32 v30, v30
    v_exp_f32 v31, v31
    s_nop 0
    v_add_f32 v28, 1.0, v28
    v_add_f32 v29, 1.0, v29
    v_add_f32 v30, 1.0, v30
    v_add_f32 v31, 1.0, v31
    v_rcp_f32 v28, v28
    v_rcp_f32 v29, v29
    v_rcp_f32 v30, v30
    v_rcp_f32 v31, v31
    s_nop 0
    v_mul_f32 v24, v24, v28
    v_mul_f32 v25, v25, v29
    v_mul_f32 v26, v26, v30
    v_mul_f32 v27, v27, v31
    v_cvt_pk_bf16_f32 v16, v24, v25
    v_cvt_pk_bf16_f32 v17, v26, v27
    ds_write_b32 v14, v16 offset:0
    ds_write_b32 v14, v17 offset:1024
P1_GO:
    buffer_load_dwordx4 v[176:179], v10, s[44:47], s7 offen offset:0
    buffer_load_dwordx4 v[180:183], v10, s[44:47], s7 offen offset:256
    buffer_load_dwordx4 v[184:187], v10, s[44:47], s7 offen offset:512
    s_add_u32 s7, s7, 3072
    buffer_load_dwordx4 v[188:191], v10, s[44:47], s7 offen offset:0
    buffer_load_dwordx4 v[192:195], v10, s[44:47], s7 offen offset:256
    buffer_load_dwordx4 v[196:199], v10, s[44:47], s7 offen offset:512
    s_add_u32 s7, s7, 3072
    buffer_load_dwordx4 v[200:203], v10, s[44:47], s7 offen offset:0
    buffer_load_dwordx4 v[204:207], v10, s[44:47], s7 offen offset:256
    buffer_load_dwordx4 v[208:211], v10, s[44:47], s7 offen offset:512
    s_add_u32 s7, s7, 3072
    buffer_load_dwordx4 v[212:215], v10, s[44:47], s7 offen offset:0
    buffer_load_dwordx4 v[216:219], v10, s[44:47], s7 offen offset:256
    buffer_load_dwordx4 v[220:223], v10, s[44:47], s7 offen offset:512
    v_lshrrev_b32 v18, 4, v1
    v_lshrrev_b32 v19, 3, v3
    v_mul_u32_u24 v20, 1056, v19
    v_and_b32 v19, 7, v3
    v_lshl_add_u32 v20, v19, 7, v20
    v_lshl_add_u32 v20, v18, 4, v20
    s_mul_i32 s12, s3, 2112
    s_add_u32 s12, s12, 25344
    v_add_u32 v22, s12, v20
    v_bfe_u32 v25, v3, 3, 1
    v_and_b32 v26, 1, v18
    v_lshl_add_u32 v25, v26, 1, v25
    v_mul_u32_u24 v24, 1056, v25
    v_bfe_u32 v25, v3, 2, 1
    v_lshl_add_u32 v24, v25, 7, v24
    v_lshrrev_b32 v25, 1, v18
    v_lshl_add_u32 v24, v25, 9, v24
    v_and_b32 v25, 3, v3
    v_lshl_add_u32 v24, v25, 3, v24
    s_lshl_b32 s12, s3, 5
    v_add_u32 v24, s12, v24
    s_waitcnt vmcnt(12)
    s_waitcnt lgkmcnt(0)
    s_barrier
    buffer_load_dwordx2 v[244:245], v15, s[52:55], 0 offen sc1
    s_cmp_eq_u32 s59, 2
    s_cbranch_scc1 P1_MM_MOD
    s_cmp_eq_u32 s59, 1
    s_cbranch_scc1 P1_MM_VO
    v_nop
    ds_read_b128 v[32:35], v20 offset:0
    ds_read_b128 v[36:39], v20 offset:2112
    ds_read_b128 v[40:43], v22 offset:0
    ds_read_b128 v[44:47], v20 offset:64
    ds_read_b128 v[48:51], v20 offset:2176
    ds_read_b128 v[52:55], v22 offset:64
    ds_read_b128 v[56:59], v20 offset:4224
    ds_read_b128 v[60:63], v20 offset:6336
    ds_read_b128 v[64:67], v22 offset:8448
    ds_read_b128 v[68:71], v20 offset:4288
    ds_read_b128 v[72:75], v20 offset:6400
    ds_read_b128 v[76:79], v22 offset:8512
    ds_read_b128 v[80:83], v20 offset:8448
    ds_read_b128 v[84:87], v20 offset:10560
    ds_read_b128 v[88:91], v22 offset:16896
    ds_read_b128 v[92:95], v20 offset:8512
    ds_read_b128 v[96:99], v20 offset:10624
    ds_read_b128 v[100:103], v22 offset:16960
    ds_read_b128 v[104:107], v20 offset:12672
    ds_read_b128 v[108:111], v20 offset:14784
    ds_read_b128 v[112:115], v22 offset:25344
    ds_read_b128 v[116:119], v20 offset:12736
    ds_read_b128 v[120:123], v20 offset:14848
    ds_read_b128 v[124:127], v22 offset:25408
    s_waitcnt lgkmcnt(15)
    v_mfma_f32_16x16x32_bf16 v[168:171], v[32:35], v[40:43], 0
    v_mfma_f32_16x16x32_bf16 v[172:175], v[36:39], v[40:43], 0
    ds_read_b128 v[32:35], v20 offset:16896
    ds_read_b128 v[36:39], v20 offset:19008
    ds_read_b128 v[40:43], v22 offset:33792
    v_mfma_f32_16x16x32_bf16 v[168:171], v[44:47], v[52:55], v[168:171]
    v_mfma_f32_16x16x32_bf16 v[172:175], v[48:51], v[52:55], v[172:175]
    ds_read_b128 v[44:47], v20 offset:16960
    ds_read_b128 v[48:51], v20 offset:19072
    ds_read_b128 v[52:55], v22 offset:33856
    v_mfma_f32_16x16x32_bf16 v[168:171], v[56:59], v[64:67], v[168:171]
    v_mfma_f32_16x16x32_bf16 v[172:175], v[60:63], v[64:67], v[172:175]
    ds_read_b128 v[56:59], v20 offset:21120
    ds_read_b128 v[60:63], v20 offset:23232
    ds_read_b128 v[64:67], v22 offset:42240
    s_waitcnt lgkmcnt(15)
    v_mfma_f32_16x16x32_bf16 v[168:171], v[68:71], v[76:79], v[168:171]
    v_mfma_f32_16x16x32_bf16 v[172:175], v[72:75], v[76:79], v[172:175]
    ds_read_b128 v[68:71], v20 offset:21184
    ds_read_b128 v[72:75], v20 offset:23296
    ds_read_b128 v[76:79], v22 offset:42304
    v_mfma_f32_16x16x32_bf16 v[168:171], v[80:83], v[88:91], v[168:171]
    v_mfma_f32_16x16x32_bf16 v[172:175], v[84:87], v[88:91], v[172:175]
    v_mfma_f32_16x16x32_bf16 v[168:171], v[92:95], v[100:103], v[168:171]
    v_mfma_f32_16x16x32_bf16 v[172:175], v[96:99], v[100:103], v[172:175]
    s_waitcnt lgkmcnt(15)
    v_mfma_f32_16x16x32_bf16 v[168:171], v[104:107], v[112:115], v[168:171]
    v_mfma_f32_16x16x32_bf16 v[172:175], v[108:111], v[112:115], v[172:175]
    s_waitcnt lgkmcnt(12)
    v_mfma_f32_16x16x32_bf16 v[168:171], v[116:119], v[124:127], v[168:171]
    v_mfma_f32_16x16x32_bf16 v[172:175], v[120:123], v[124:127], v[172:175]
    s_waitcnt lgkmcnt(9)
    v_mfma_f32_16x16x32_bf16 v[168:171], v[32:35], v[40:43], v[168:171]
    v_mfma_f32_16x16x32_bf16 v[172:175], v[36:39], v[40:43], v[172:175]
    s_waitcnt lgkmcnt(6)
    v_mfma_f32_16x16x32_bf16 v[168:171], v[44:47], v[52:55], v[168:171]
    v_mfma_f32_16x16x32_bf16 v[172:175], v[48:51], v[52:55], v[172:175]
    s_waitcnt lgkmcnt(3)
    v_mfma_f32_16x16x32_bf16 v[168:171], v[56:59], v[64:67], v[168:171]
    v_mfma_f32_16x16x32_bf16 v[172:175], v[60:63], v[64:67], v[172:175]
    s_waitcnt lgkmcnt(0)
    v_mfma_f32_16x16x32_bf16 v[168:171], v[68:71], v[76:79], v[168:171]
    v_mfma_f32_16x16x32_bf16 v[172:175], v[72:75], v[76:79], v[172:175]
    s_mov_b32 s12, 0x3d96c740
    s_branch P1_EPI
P1_MM_VO:
    v_add_u32 v25, 25344, v24
    ds_read_b128 v[32:35], v20 offset:0
    ds_read_b128 v[36:39], v20 offset:2112
    ds_read_b64_tr_b16 v[40:41], v25 offset:0
    ds_read_b64_tr_b16 v[42:43], v25 offset:256
    ds_read_b128 v[44:47], v20 offset:64
    ds_read_b128 v[48:51], v20 offset:2176
    ds_read_b64_tr_b16 v[52:53], v25 offset:4224
    ds_read_b64_tr_b16 v[54:55], v25 offset:4480
    ds_read_b128 v[56:59], v20 offset:4224
    ds_read_b128 v[60:63], v20 offset:6336
    ds_read_b64_tr_b16 v[64:65], v25 offset:8448
    ds_read_b64_tr_b16 v[66:67], v25 offset:8704
    ds_read_b128 v[68:71], v20 offset:4288
    ds_read_b128 v[72:75], v20 offset:6400
    ds_read_b64_tr_b16 v[76:77], v25 offset:12672
    ds_read_b64_tr_b16 v[78:79], v25 offset:12928
    ds_read_b128 v[80:83], v20 offset:8448
    ds_read_b128 v[84:87], v20 offset:10560
    ds_read_b64_tr_b16 v[88:89], v25 offset:16896
    ds_read_b64_tr_b16 v[90:91], v25 offset:17152
    ds_read_b128 v[92:95], v20 offset:8512
    ds_read_b128 v[96:99], v20 offset:10624
    ds_read_b64_tr_b16 v[100:101], v25 offset:21120
    ds_read_b64_tr_b16 v[102:103], v25 offset:21376
    ds_read_b128 v[104:107], v20 offset:12672
    ds_read_b128 v[108:111], v20 offset:14784
    ds_read_b64_tr_b16 v[112:113], v25 offset:25344
    ds_read_b64_tr_b16 v[114:115], v25 offset:25600
    ds_read_b128 v[116:119], v20 offset:12736
    ds_read_b128 v[120:123], v20 offset:14848
    ds_read_b64_tr_b16 v[124:125], v25 offset:29568
    ds_read_b64_tr_b16 v[126:127], v25 offset:29824
    s_waitcnt lgkmcnt(15)
    v_mfma_f32_16x16x32_bf16 v[168:171], v[32:35], v[40:43], 0
    v_mfma_f32_16x16x32_bf16 v[172:175], v[36:39], v[40:43], 0
    ds_read_b128 v[32:35], v20 offset:16896
    ds_read_b128 v[36:39], v20 offset:19008
    ds_read_b64_tr_b16 v[40:41], v25 offset:33792
    ds_read_b64_tr_b16 v[42:43], v25 offset:34048
    v_mfma_f32_16x16x32_bf16 v[168:171], v[44:47], v[52:55], v[168:171]
    v_mfma_f32_16x16x32_bf16 v[172:175], v[48:51], v[52:55], v[172:175]
    ds_read_b128 v[44:47], v20 offset:16960
    ds_read_b128 v[48:51], v20 offset:19072
    ds_read_b64_tr_b16 v[52:53], v25 offset:38016
    ds_read_b64_tr_b16 v[54:55], v25 offset:38272
    v_mfma_f32_16x16x32_bf16 v[168:171], v[56:59], v[64:67], v[168:171]
    v_mfma_f32_16x16x32_bf16 v[172:175], v[60:63], v[64:67], v[172:175]
    ds_read_b128 v[56:59], v20 offset:21120
    ds_read_b128 v[60:63], v20 offset:23232
    ds_read_b64_tr_b16 v[64:65], v25 offset:42240
    ds_read_b64_tr_b16 v[66:67], v25 offset:42496
    v_mfma_f32_16x16x32_bf16 v[168:171], v[68:71], v[76:79], v[168:171]
    v_mfma_f32_16x16x32_bf16 v[172:175], v[72:75], v[76:79], v[172:175]
    ds_read_b128 v[68:71], v20 offset:21184
    ds_read_b128 v[72:75], v20 offset:23296
    ds_read_b64_tr_b16 v[76:77], v25 offset:46464
    ds_read_b64_tr_b16 v[78:79], v25 offset:46720
    s_waitcnt lgkmcnt(15)
    v_mfma_f32_16x16x32_bf16 v[168:171], v[80:83], v[88:91], v[168:171]
    v_mfma_f32_16x16x32_bf16 v[172:175], v[84:87], v[88:91], v[172:175]
    v_mfma_f32_16x16x32_bf16 v[168:171], v[92:95], v[100:103], v[168:171]
    v_mfma_f32_16x16x32_bf16 v[172:175], v[96:99], v[100:103], v[172:175]
    v_mfma_f32_16x16x32_bf16 v[168:171], v[104:107], v[112:115], v[168:171]
    v_mfma_f32_16x16x32_bf16 v[172:175], v[108:111], v[112:115], v[172:175]
    v_mfma_f32_16x16x32_bf16 v[168:171], v[116:119], v[124:127], v[168:171]
    v_mfma_f32_16x16x32_bf16 v[172:175], v[120:123], v[124:127], v[172:175]
    s_waitcnt lgkmcnt(12)
    v_mfma_f32_16x16x32_bf16 v[168:171], v[32:35], v[40:43], v[168:171]
    v_mfma_f32_16x16x32_bf16 v[172:175], v[36:39], v[40:43], v[172:175]
    s_waitcnt lgkmcnt(8)
    v_mfma_f32_16x16x32_bf16 v[168:171], v[44:47], v[52:55], v[168:171]
    v_mfma_f32_16x16x32_bf16 v[172:175], v[48:51], v[52:55], v[172:175]
    s_waitcnt lgkmcnt(4)
    v_mfma_f32_16x16x32_bf16 v[168:171], v[56:59], v[64:67], v[168:171]
    v_mfma_f32_16x16x32_bf16 v[172:175], v[60:63], v[64:67], v[172:175]
    s_waitcnt lgkmcnt(0)
    v_mfma_f32_16x16x32_bf16 v[168:171], v[68:71], v[76:79], v[168:171]
    v_mfma_f32_16x16x32_bf16 v[172:175], v[72:75], v[76:79], v[172:175]
    s_mov_b32 s12, 1.0
P1_EPI:
    v_and_b32 v26, 1, v18
    v_lshlrev_b32 v26, 10, v26
    v_lshrrev_b32 v27, 1, v18
    v_lshl_add_u32 v26, v27, 9, v26
    v_lshl_add_u32 v26, v3, 4, v26
    s_lshl_b32 s10, s9, 1
    s_lshr_b32 s11, s3, 1
    s_add_u32 s10, s10, s11
    s_mul_i32 s11, s59, 12
    s_add_u32 s10, s10, s11
    s_mul_i32 s10, s10, 24576
    s_lshl_b32 s11, s8, 11
    s_add_u32 s10, s10, s11
    s_and_b32 s11, s3, 1
    s_lshl_b32 s11, s11, 8
    s_add_u32 s10, s10, s11
    s_add_u32 s10, s10, 16384
    v_mul_f32 v72, s12, v168
    v_mul_f32 v73, s12, v169
    v_mul_f32 v74, s12, v170
    v_mul_f32 v75, s12, v171
    v_mul_f32 v76, s12, v172
    v_mul_f32 v77, s12, v173
    v_mul_f32 v78, s12, v174
    v_mul_f32 v79, s12, v175
    v_cvt_pk_bf16_f32 v28, v72, v73
    v_cvt_pk_bf16_f32 v29, v74, v75
    v_cvt_pk_bf16_f32 v30, v76, v77
    v_cvt_pk_bf16_f32 v31, v78, v79
    s_mul_i32 s14, s59, 6
    s_add_u32 s14, s14, s9
    s_mul_i32 s14, s14, 12
    s_add_u32 s14, s14, s8
    s_lshl_b32 s14, s14, 6
    s_add_u32 s14, s14, 10485760
    v_permlane16_swap_b32 v28, v30
    v_permlane16_swap_b32 v29, v31
    s_nop 1
    buffer_store_dwordx4 v[28:31], v26, s[40:43], s10 offen sc1
    s_branch P1_FLAG
P1_MM_MOD:
    v_mov_b32 v80, 0
    v_mov_b32 v81, 0
    v_mov_b32 v82, 0
    v_mov_b32 v83, 0
    v_mov_b32 v84, 0
    v_mov_b32 v85, 0
    v_mov_b32 v86, 0
    v_mov_b32 v87, 0
    v_mov_b32 v88, 0
    v_mov_b32 v89, 0
    v_mov_b32 v90, 0
    v_mov_b32 v91, 0
    v_mov_b32 v92, 0
    v_mov_b32 v93, 0
    v_mov_b32 v94, 0
    v_mov_b32 v95, 0
    v_mov_b32 v96, 0
    v_mov_b32 v97, 0
    v_mov_b32 v98, 0
    v_mov_b32 v99, 0
    v_mov_b32 v100, 0
    v_mov_b32 v101, 0
    v_mov_b32 v102, 0
    v_mov_b32 v103, 0
    v_mov_b32 v104, 0
    v_mov_b32 v105, 0
    v_mov_b32 v106, 0
    v_mov_b32 v107, 0
    v_mov_b32 v108, 0
    v_mov_b32 v109, 0
    v_mov_b32 v110, 0
    v_mov_b32 v111, 0
    v_mov_b32 v112, 0
    v_mov_b32 v113, 0
    v_mov_b32 v114, 0
    v_mov_b32 v115, 0
    v_mov_b32 v116, 0
    v_mov_b32 v117, 0
    v_mov_b32 v118, 0
    v_mov_b32 v119, 0
    v_mov_b32 v120, 0
    v_mov_b32 v121, 0
    v_mov_b32 v122, 0
    v_mov_b32 v123, 0
    v_mov_b32 v124, 0
    v_mov_b32 v125, 0
    v_mov_b32 v126, 0
    v_mov_b32 v127, 0
    v_lshlrev_b32 v26, 10, v3
    v_lshl_add_u32 v26, v18, 4, v26
    v_cmp_gt_u32 vcc, 2, v3
    s_and_saveexec_b64 s[10:11], vcc
    ds_read_b128 v[80:83], v26 offset:0
    ds_read_b128 v[84:87], v26 offset:64
    ds_read_b128 v[88:91], v26 offset:128
    ds_read_b128 v[92:95], v26 offset:192
    ds_read_b128 v[96:99], v26 offset:256
    ds_read_b128 v[100:103], v26 offset:320
    ds_read_b128 v[104:107], v26 offset:384
    ds_read_b128 v[108:111], v26 offset:448
    ds_read_b128 v[112:115], v26 offset:512
    ds_read_b128 v[116:119], v26 offset:576
    ds_read_b128 v[120:123], v26 offset:640
    ds_read_b128 v[124:127], v26 offset:704
    s_mov_b64 exec, s[10:11]
    s_waitcnt lgkmcnt(0)
    v_add_u32 v25, 25344, v24
    ds_read_b64_tr_b16 v[40:41], v25 offset:0
    ds_read_b64_tr_b16 v[42:43], v25 offset:256
    ds_read_b64_tr_b16 v[52:53], v25 offset:4224
    ds_read_b64_tr_b16 v[54:55], v25 offset:4480
    ds_read_b64_tr_b16 v[64:65], v25 offset:8448
    ds_read_b64_tr_b16 v[66:67], v25 offset:8704
    ds_read_b64_tr_b16 v[76:77], v25 offset:12672
    ds_read_b64_tr_b16 v[78:79], v25 offset:12928
    s_waitcnt lgkmcnt(6)
    v_mfma_f32_16x16x32_bf16 v[168:171], v[80:83], v[40:43], 0
    ds_read_b64_tr_b16 v[40:41], v25 offset:16896
    ds_read_b64_tr_b16 v[42:43], v25 offset:17152
    s_waitcnt lgkmcnt(6)
    v_mfma_f32_16x16x32_bf16 v[168:171], v[84:87], v[52:55], v[168:171]
    ds_read_b64_tr_b16 v[52:53], v25 offset:21120
    ds_read_b64_tr_b16 v[54:55], v25 offset:21376
    s_waitcnt lgkmcnt(6)
    v_mfma_f32_16x16x32_bf16 v[168:171], v[88:91], v[64:67], v[168:171]
    ds_read_b64_tr_b16 v[64:65], v25 offset:25344
    ds_read_b64_tr_b16 v[66:67], v25 offset:25600
    s_waitcnt lgkmcnt(6)
    v_mfma_f32_16x16x32_bf16 v[168:171], v[92:95], v[76:79], v[168:171]
    ds_read_b64_tr_b16 v[76:77], v25 offset:29568
    ds_read_b64_tr_b16 v[78:79], v25 offset:29824
    s_waitcnt lgkmcnt(6)
    v_mfma_f32_16x16x32_bf16 v[168:171], v[96:99], v[40:43], v[168:171]
    ds_read_b64_tr_b16 v[40:41], v25 offset:33792
    ds_read_b64_tr_b16 v[42:43], v25 offset:34048
    s_waitcnt lgkmcnt(6)
    v_mfma_f32_16x16x32_bf16 v[168:171], v[100:103], v[52:55], v[168:171]
    ds_read_b64_tr_b16 v[52:53], v25 offset:38016
    ds_read_b64_tr_b16 v[54:55], v25 offset:38272
    s_waitcnt lgkmcnt(6)
    v_mfma_f32_16x16x32_bf16 v[168:171], v[104:107], v[64:67], v[168:171]
    ds_read_b64_tr_b16 v[64:65], v25 offset:42240
    ds_read_b64_tr_b16 v[66:67], v25 offset:42496
    s_waitcnt lgkmcnt(6)
    v_mfma_f32_16x16x32_bf16 v[168:171], v[108:111], v[76:79], v[168:171]
    ds_read_b64_tr_b16 v[76:77], v25 offset:46464
    ds_read_b64_tr_b16 v[78:79], v25 offset:46720
    s_waitcnt lgkmcnt(6)
    v_mfma_f32_16x16x32_bf16 v[168:171], v[112:115], v[40:43], v[168:171]
    s_waitcnt lgkmcnt(4)
    v_mfma_f32_16x16x32_bf16 v[168:171], v[116:119], v[52:55], v[168:171]
    s_waitcnt lgkmcnt(2)
    v_mfma_f32_16x16x32_bf16 v[168:171], v[120:123], v[64:67], v[168:171]
    s_waitcnt lgkmcnt(0)
    v_mfma_f32_16x16x32_bf16 v[168:171], v[124:127], v[76:79], v[168:171]
    s_sub_u32 s10, s9, 6
    s_cmp_lt_u32 s10, 6
    s_cselect_b32 s12, 1.0, 0
    s_lshl_b32 s10, s9, 8
    s_lshl_b32 s11, s3, 6
    s_add_u32 s10, s10, s11
    s_add_u32 s10, s10, 0
    s_add_u32 s11, s10, 4608
    v_lshlrev_b32 v26, 2, v1
    v_cmp_gt_u32 vcc, 16, v1
    s_lshl_b32 s14, s9, 6
    s_add_u32 s14, s14, 10494976
    v_add_f32 v72, s12, v168
    v_add_f32 v73, s12, v169
    s_and_saveexec_b64 s[12:13], vcc
    buffer_store_dword v72, v26, s[40:43], s10 offen sc1
    buffer_store_dword v73, v26, s[40:43], s11 offen sc1
    s_mov_b64 exec, s[12:13]
P1_FLAG:
    s_waitcnt vmcnt(0)
    s_barrier
    s_cmp_lg_u32 s3, 0
    s_cbranch_scc1 F1_SKIP
    s_cmp_eq_u32 s70, 1
    s_cbranch_scc1 F1_NOK
    s_mov_b32 s58, 0
    s_waitcnt vmcnt(0)
F1_NCHK:
    v_readfirstlane_b32 s68, v244
    v_readfirstlane_b32 s69, v245
    s_add_u32 s58, s58, 1
    s_cmp_gt_u32 s58, 100000
    s_cbranch_scc1 F1_NSET
    s_cmp_lg_u32 s68, 0
    s_cbranch_scc1 F1_NSET
    buffer_load_dwordx2 v[244:245], v15, s[52:55], 0 offen sc1
    s_waitcnt vmcnt(0)
    s_branch F1_NCHK
F1_NSET:
    s_mov_b32 s70, 1
F1_NOK:
    v_mov_b32 v34, s68
    v_mov_b32 v35, s69
    s_mov_b64 exec, 1
    buffer_store_dwordx2 v[34:35], v15, s[40:43], s14 offen sc0 sc1
    s_mov_b64 exec, -1
    s_nop 1
F1_SKIP:
    s_mov_b32 s57, 1
    s_branch P1_LN
P1_IDLE:
    buffer_load_dwordx4 v[176:179], v10, s[44:47], s7 offen offset:0
    buffer_load_dwordx4 v[180:183], v10, s[44:47], s7 offen offset:256
    buffer_load_dwordx4 v[184:187], v10, s[44:47], s7 offen offset:512
    s_add_u32 s7, s7, 3072
    buffer_load_dwordx4 v[188:191], v10, s[44:47], s7 offen offset:0
    buffer_load_dwordx4 v[192:195], v10, s[44:47], s7 offen offset:256
    buffer_load_dwordx4 v[196:199], v10, s[44:47], s7 offen offset:512
    s_add_u32 s7, s7, 3072
    buffer_load_dwordx4 v[200:203], v10, s[44:47], s7 offen offset:0
    buffer_load_dwordx4 v[204:207], v10, s[44:47], s7 offen offset:256
    buffer_load_dwordx4 v[208:211], v10, s[44:47], s7 offen offset:512
    s_add_u32 s7, s7, 3072
    buffer_load_dwordx4 v[212:215], v10, s[44:47], s7 offen offset:0
    buffer_load_dwordx4 v[216:219], v10, s[44:47], s7 offen offset:256
    buffer_load_dwordx4 v[220:223], v10, s[44:47], s7 offen offset:512
    s_waitcnt vmcnt(0)
    buffer_load_dwordx2 v[244:245], v15, s[52:55], 0 offen sc1
    s_cmp_ge_u32 s5, 6
    s_cselect_b32 s57, 2, 0
    s_lshl_b32 s14, s4, 1
    s_and_b32 s11, s5, 1
    s_add_u32 s14, s14, s11
    s_lshl_b32 s14, s14, 6
    s_add_u32 s14, s14, 10496128
P1_LN:
    v_lshlrev_b32 v80, 16, v176
    v_and_b32 v81, 0xffff0000, v176
    v_lshlrev_b32 v82, 16, v177
    v_and_b32 v83, 0xffff0000, v177
    v_lshlrev_b32 v84, 16, v178
    v_and_b32 v85, 0xffff0000, v178
    v_lshlrev_b32 v86, 16, v179
    v_and_b32 v87, 0xffff0000, v179
    v_lshlrev_b32 v88, 16, v180
    v_and_b32 v89, 0xffff0000, v180
    v_lshlrev_b32 v90, 16, v181
    v_and_b32 v91, 0xffff0000, v181
    v_lshlrev_b32 v92, 16, v182
    v_and_b32 v93, 0xffff0000, v182
    v_lshlrev_b32 v94, 16, v183
    v_and_b32 v95, 0xffff0000, v183
    v_lshlrev_b32 v96, 16, v184
    v_and_b32 v97, 0xffff0000, v184
    v_lshlrev_b32 v98, 16, v185
    v_and_b32 v99, 0xffff0000, v185
    v_lshlrev_b32 v100, 16, v186
    v_and_b32 v101, 0xffff0000, v186
    v_lshlrev_b32 v102, 16, v187
    v_and_b32 v103, 0xffff0000, v187
    v_pk_add_f32 v[32:33], v[80:81], v[82:83]
    v_pk_add_f32 v[34:35], v[84:85], v[86:87]
    v_pk_add_f32 v[32:33], v[32:33], v[88:89]
    v_pk_add_f32 v[34:35], v[34:35], v[90:91]
    v_pk_add_f32 v[32:33], v[32:33], v[92:93]
    v_pk_add_f32 v[34:35], v[34:35], v[94:95]
    v_pk_add_f32 v[32:33], v[32:33], v[96:97]
    v_pk_add_f32 v[34:35], v[34:35], v[98:99]
    v_pk_add_f32 v[32:33], v[32:33], v[100:101]
    v_pk_add_f32 v[34:35], v[34:35], v[102:103]
    v_pk_add_f32 v[32:33], v[32:33], v[34:35]
    v_add_f32 v40, v32, v33
    v_lshlrev_b32 v104, 16, v188
    v_and_b32 v105, 0xffff0000, v188
    v_lshlrev_b32 v106, 16, v189
    v_and_b32 v107, 0xffff0000, v189
    v_lshlrev_b32 v108, 16, v190
    v_and_b32 v109, 0xffff0000, v190
    v_lshlrev_b32 v110, 16, v191
    v_and_b32 v111, 0xffff0000, v191
    v_lshlrev_b32 v112, 16, v192
    v_and_b32 v113, 0xffff0000, v192
    v_lshlrev_b32 v114, 16, v193
    v_and_b32 v115, 0xffff0000, v193
    v_lshlrev_b32 v116, 16, v194
    v_and_b32 v117, 0xffff0000, v194
    v_lshlrev_b32 v118, 16, v195
    v_and_b32 v119, 0xffff0000, v195
    v_lshlrev_b32 v120, 16, v196
    v_and_b32 v121, 0xffff0000, v196
    v_lshlrev_b32 v122, 16, v197
    v_and_b32 v123, 0xffff0000, v197
    v_lshlrev_b32 v124, 16, v198
    v_and_b32 v125, 0xffff0000, v198
    v_lshlrev_b32 v126, 16, v199
    v_and_b32 v127, 0xffff0000, v199
    v_pk_add_f32 v[32:33], v[104:105], v[106:107]
    v_pk_add_f32 v[34:35], v[108:109], v[110:111]
    v_pk_add_f32 v[32:33], v[32:33], v[112:113]
    v_pk_add_f32 v[34:35], v[34:35], v[114:115]
    v_pk_add_f32 v[32:33], v[32:33], v[116:117]
    v_pk_add_f32 v[34:35], v[34:35], v[118:119]
    v_pk_add_f32 v[32:33], v[32:33], v[120:121]
    v_pk_add_f32 v[34:35], v[34:35], v[122:123]
    v_pk_add_f32 v[32:33], v[32:33], v[124:125]
    v_pk_add_f32 v[34:35], v[34:35], v[126:127]
    v_pk_add_f32 v[32:33], v[32:33], v[34:35]
    v_add_f32 v42, v32, v33
    v_lshlrev_b32 v128, 16, v200
    v_and_b32 v129, 0xffff0000, v200
    v_lshlrev_b32 v130, 16, v201
    v_and_b32 v131, 0xffff0000, v201
    v_lshlrev_b32 v132, 16, v202
    v_and_b32 v133, 0xffff0000, v202
    v_lshlrev_b32 v134, 16, v203
    v_and_b32 v135, 0xffff0000, v203
    v_lshlrev_b32 v136, 16, v204
    v_and_b32 v137, 0xffff0000, v204
    v_lshlrev_b32 v138, 16, v205
    v_and_b32 v139, 0xffff0000, v205
    v_lshlrev_b32 v140, 16, v206
    v_and_b32 v141, 0xffff0000, v206
    v_lshlrev_b32 v142, 16, v207
    v_and_b32 v143, 0xffff0000, v207
    v_lshlrev_b32 v144, 16, v208
    v_and_b32 v145, 0xffff0000, v208
    v_lshlrev_b32 v146, 16, v209
    v_and_b32 v147, 0xffff0000, v209
    v_lshlrev_b32 v148, 16, v210
    v_and_b32 v149, 0xffff0000, v210
    v_lshlrev_b32 v150, 16, v211
    v_and_b32 v151, 0xffff0000, v211
    v_pk_add_f32 v[32:33], v[128:129], v[130:131]
    v_pk_add_f32 v[34:35], v[132:133], v[134:135]
    v_pk_add_f32 v[32:33], v[32:33], v[136:137]
    v_pk_add_f32 v[34:35], v[34:35], v[138:139]
    v_pk_add_f32 v[32:33], v[32:33], v[140:141]
    v_pk_add_f32 v[34:35], v[34:35], v[142:143]
    v_pk_add_f32 v[32:33], v[32:33], v[144:145]
    v_pk_add_f32 v[34:35], v[34:35], v[146:147]
    v_pk_add_f32 v[32:33], v[32:33], v[148:149]
    v_pk_add_f32 v[34:35], v[34:35], v[150:151]
    v_pk_add_f32 v[32:33], v[32:33], v[34:35]
    v_add_f32 v44, v32, v33
    v_lshlrev_b32 v152, 16, v212
    v_and_b32 v153, 0xffff0000, v212
    v_lshlrev_b32 v154, 16, v213
    v_and_b32 v155, 0xffff0000, v213
    v_lshlrev_b32 v156, 16, v214
    v_and_b32 v157, 0xffff0000, v214
    v_lshlrev_b32 v158, 16, v215
    v_and_b32 v159, 0xffff0000, v215
    v_lshlrev_b32 v160, 16, v216
    v_and_b32 v161, 0xffff0000, v216
    v_lshlrev_b32 v162, 16, v217
    v_and_b32 v163, 0xffff0000, v217
    v_lshlrev_b32 v164, 16, v218
    v_and_b32 v165, 0xffff0000, v218
    v_lshlrev_b32 v166, 16, v219
    v_and_b32 v167, 0xffff0000, v219
    v_lshlrev_b32 v168, 16, v220
    v_and_b32 v169, 0xffff0000, v220
    v_lshlrev_b32 v170, 16, v221
    v_and_b32 v171, 0xffff0000, v221
    v_lshlrev_b32 v172, 16, v222
    v_and_b32 v173, 0xffff0000, v222
    v_lshlrev_b32 v174, 16, v223
    v_and_b32 v175, 0xffff0000, v223
    v_pk_add_f32 v[32:33], v[152:153], v[154:155]
    v_pk_add_f32 v[34:35], v[156:157], v[158:159]
    v_pk_add_f32 v[32:33], v[32:33], v[160:161]
    v_pk_add_f32 v[34:35], v[34:35], v[162:163]
    v_pk_add_f32 v[32:33], v[32:33], v[164:165]
    v_pk_add_f32 v[34:35], v[34:35], v[166:167]
    v_pk_add_f32 v[32:33], v[32:33], v[168:169]
    v_pk_add_f32 v[34:35], v[34:35], v[170:171]
    v_pk_add_f32 v[32:33], v[32:33], v[172:173]
    v_pk_add_f32 v[34:35], v[34:35], v[174:175]
    v_pk_add_f32 v[32:33], v[32:33], v[34:35]
    v_add_f32 v46, v32, v33
    s_nop 0
    v_add_f32_dpp v40, v40, v40 row_ror:8 row_mask:0xf bank_mask:0xf
    v_add_f32_dpp v42, v42, v42 row_ror:8 row_mask:0xf bank_mask:0xf
    v_add_f32_dpp v44, v44, v44 row_ror:8 row_mask:0xf bank_mask:0xf
    v_add_f32_dpp v46, v46, v46 row_ror:8 row_mask:0xf bank_mask:0xf
    v_add_f32_dpp v40, v40, v40 row_ror:4 row_mask:0xf bank_mask:0xf
    v_add_f32_dpp v42, v42, v42 row_ror:4 row_mask:0xf bank_mask:0xf
    v_add_f32_dpp v44, v44, v44 row_ror:4 row_mask:0xf bank_mask:0xf
    v_add_f32_dpp v46, v46, v46 row_ror:4 row_mask:0xf bank_mask:0xf
    v_add_f32_dpp v40, v40, v40 row_ror:2 row_mask:0xf bank_mask:0xf
    v_add_f32_dpp v42, v42, v42 row_ror:2 row_mask:0xf bank_mask:0xf
    v_add_f32_dpp v44, v44, v44 row_ror:2 row_mask:0xf bank_mask:0xf
    v_add_f32_dpp v46, v46, v46 row_ror:2 row_mask:0xf bank_mask:0xf
    v_add_f32_dpp v40, v40, v40 row_ror:1 row_mask:0xf bank_mask:0xf
    v_add_f32_dpp v42, v42, v42 row_ror:1 row_mask:0xf bank_mask:0xf
    v_add_f32_dpp v44, v44, v44 row_ror:1 row_mask:0xf bank_mask:0xf
    v_add_f32_dpp v46, v46, v46 row_ror:1 row_mask:0xf bank_mask:0xf
    v_mul_f32 v40, 0x3b2aaaab, v40
    v_pk_add_f32 v[80:81], v[80:81], v[40:41] op_sel_hi:[1,0] neg_lo:[0,1] neg_hi:[0,1]
    v_pk_add_f32 v[82:83], v[82:83], v[40:41] op_sel_hi:[1,0] neg_lo:[0,1] neg_hi:[0,1]
    v_pk_add_f32 v[84:85], v[84:85], v[40:41] op_sel_hi:[1,0] neg_lo:[0,1] neg_hi:[0,1]
    v_pk_add_f32 v[86:87], v[86:87], v[40:41] op_sel_hi:[1,0] neg_lo:[0,1] neg_hi:[0,1]
    v_pk_add_f32 v[88:89], v[88:89], v[40:41] op_sel_hi:[1,0] neg_lo:[0,1] neg_hi:[0,1]
    v_pk_add_f32 v[90:91], v[90:91], v[40:41] op_sel_hi:[1,0] neg_lo:[0,1] neg_hi:[0,1]
    v_pk_add_f32 v[92:93], v[92:93], v[40:41] op_sel_hi:[1,0] neg_lo:[0,1] neg_hi:[0,1]
    v_pk_add_f32 v[94:95], v[94:95], v[40:41] op_sel_hi:[1,0] neg_lo:[0,1] neg_hi:[0,1]
    v_pk_add_f32 v[96:97], v[96:97], v[40:41] op_sel_hi:[1,0] neg_lo:[0,1] neg_hi:[0,1]
    v_pk_add_f32 v[98:99], v[98:99], v[40:41] op_sel_hi:[1,0] neg_lo:[0,1] neg_hi:[0,1]
    v_pk_add_f32 v[100:101], v[100:101], v[40:41] op_sel_hi:[1,0] neg_lo:[0,1] neg_hi:[0,1]
    v_pk_add_f32 v[102:103], v[102:103], v[40:41] op_sel_hi:[1,0] neg_lo:[0,1] neg_hi:[0,1]
    v_pk_mul_f32 v[32:33], v[80:81], v[80:81]
    v_pk_mul_f32 v[34:35], v[82:83], v[82:83]
    v_pk_fma_f32 v[32:33], v[84:85], v[84:85], v[32:33]
    v_pk_fma_f32 v[34:35], v[86:87], v[86:87], v[34:35]
    v_pk_fma_f32 v[32:33], v[88:89], v[88:89], v[32:33]
    v_pk_fma_f32 v[34:35], v[90:91], v[90:91], v[34:35]
    v_pk_fma_f32 v[32:33], v[92:93], v[92:93], v[32:33]
    v_pk_fma_f32 v[34:35], v[94:95], v[94:95], v[34:35]
    v_pk_fma_f32 v[32:33], v[96:97], v[96:97], v[32:33]
    v_pk_fma_f32 v[34:35], v[98:99], v[98:99], v[34:35]
    v_pk_fma_f32 v[32:33], v[100:101], v[100:101], v[32:33]
    v_pk_fma_f32 v[34:35], v[102:103], v[102:103], v[34:35]
    v_pk_add_f32 v[32:33], v[32:33], v[34:35]
    v_add_f32 v48, v32, v33
    v_mul_f32 v42, 0x3b2aaaab, v42
    v_pk_add_f32 v[104:105], v[104:105], v[42:43] op_sel_hi:[1,0] neg_lo:[0,1] neg_hi:[0,1]
    v_pk_add_f32 v[106:107], v[106:107], v[42:43] op_sel_hi:[1,0] neg_lo:[0,1] neg_hi:[0,1]
    v_pk_add_f32 v[108:109], v[108:109], v[42:43] op_sel_hi:[1,0] neg_lo:[0,1] neg_hi:[0,1]
    v_pk_add_f32 v[110:111], v[110:111], v[42:43] op_sel_hi:[1,0] neg_lo:[0,1] neg_hi:[0,1]
    v_pk_add_f32 v[112:113], v[112:113], v[42:43] op_sel_hi:[1,0] neg_lo:[0,1] neg_hi:[0,1]
    v_pk_add_f32 v[114:115], v[114:115], v[42:43] op_sel_hi:[1,0] neg_lo:[0,1] neg_hi:[0,1]
    v_pk_add_f32 v[116:117], v[116:117], v[42:43] op_sel_hi:[1,0] neg_lo:[0,1] neg_hi:[0,1]
    v_pk_add_f32 v[118:119], v[118:119], v[42:43] op_sel_hi:[1,0] neg_lo:[0,1] neg_hi:[0,1]
    v_pk_add_f32 v[120:121], v[120:121], v[42:43] op_sel_hi:[1,0] neg_lo:[0,1] neg_hi:[0,1]
    v_pk_add_f32 v[122:123], v[122:123], v[42:43] op_sel_hi:[1,0] neg_lo:[0,1] neg_hi:[0,1]
    v_pk_add_f32 v[124:125], v[124:125], v[42:43] op_sel_hi:[1,0] neg_lo:[0,1] neg_hi:[0,1]
    v_pk_add_f32 v[126:127], v[126:127], v[42:43] op_sel_hi:[1,0] neg_lo:[0,1] neg_hi:[0,1]
    v_pk_mul_f32 v[32:33], v[104:105], v[104:105]
    v_pk_mul_f32 v[34:35], v[106:107], v[106:107]
    v_pk_fma_f32 v[32:33], v[108:109], v[108:109], v[32:33]
    v_pk_fma_f32 v[34:35], v[110:111], v[110:111], v[34:35]
    v_pk_fma_f32 v[32:33], v[112:113], v[112:113], v[32:33]
    v_pk_fma_f32 v[34:35], v[114:115], v[114:115], v[34:35]
    v_pk_fma_f32 v[32:33], v[116:117], v[116:117], v[32:33]
    v_pk_fma_f32 v[34:35], v[118:119], v[118:119], v[34:35]
    v_pk_fma_f32 v[32:33], v[120:121], v[120:121], v[32:33]
    v_pk_fma_f32 v[34:35], v[122:123], v[122:123], v[34:35]
    v_pk_fma_f32 v[32:33], v[124:125], v[124:125], v[32:33]
    v_pk_fma_f32 v[34:35], v[126:127], v[126:127], v[34:35]
    v_pk_add_f32 v[32:33], v[32:33], v[34:35]
    v_add_f32 v50, v32, v33
    v_mul_f32 v44, 0x3b2aaaab, v44
    v_pk_add_f32 v[128:129], v[128:129], v[44:45] op_sel_hi:[1,0] neg_lo:[0,1] neg_hi:[0,1]
    v_pk_add_f32 v[130:131], v[130:131], v[44:45] op_sel_hi:[1,0] neg_lo:[0,1] neg_hi:[0,1]
    v_pk_add_f32 v[132:133], v[132:133], v[44:45] op_sel_hi:[1,0] neg_lo:[0,1] neg_hi:[0,1]
    v_pk_add_f32 v[134:135], v[134:135], v[44:45] op_sel_hi:[1,0] neg_lo:[0,1] neg_hi:[0,1]
    v_pk_add_f32 v[136:137], v[136:137], v[44:45] op_sel_hi:[1,0] neg_lo:[0,1] neg_hi:[0,1]
    v_pk_add_f32 v[138:139], v[138:139], v[44:45] op_sel_hi:[1,0] neg_lo:[0,1] neg_hi:[0,1]
    v_pk_add_f32 v[140:141], v[140:141], v[44:45] op_sel_hi:[1,0] neg_lo:[0,1] neg_hi:[0,1]
    v_pk_add_f32 v[142:143], v[142:143], v[44:45] op_sel_hi:[1,0] neg_lo:[0,1] neg_hi:[0,1]
    v_pk_add_f32 v[144:145], v[144:145], v[44:45] op_sel_hi:[1,0] neg_lo:[0,1] neg_hi:[0,1]
    v_pk_add_f32 v[146:147], v[146:147], v[44:45] op_sel_hi:[1,0] neg_lo:[0,1] neg_hi:[0,1]
    v_pk_add_f32 v[148:149], v[148:149], v[44:45] op_sel_hi:[1,0] neg_lo:[0,1] neg_hi:[0,1]
    v_pk_add_f32 v[150:151], v[150:151], v[44:45] op_sel_hi:[1,0] neg_lo:[0,1] neg_hi:[0,1]
    v_pk_mul_f32 v[32:33], v[128:129], v[128:129]
    v_pk_mul_f32 v[34:35], v[130:131], v[130:131]
    v_pk_fma_f32 v[32:33], v[132:133], v[132:133], v[32:33]
    v_pk_fma_f32 v[34:35], v[134:135], v[134:135], v[34:35]
    v_pk_fma_f32 v[32:33], v[136:137], v[136:137], v[32:33]
    v_pk_fma_f32 v[34:35], v[138:139], v[138:139], v[34:35]
    v_pk_fma_f32 v[32:33], v[140:141], v[140:141], v[32:33]
    v_pk_fma_f32 v[34:35], v[142:143], v[142:143], v[34:35]
    v_pk_fma_f32 v[32:33], v[144:145], v[144:145], v[32:33]
    v_pk_fma_f32 v[34:35], v[146:147], v[146:147], v[34:35]
    v_pk_fma_f32 v[32:33], v[148:149], v[148:149], v[32:33]
    v_pk_fma_f32 v[34:35], v[150:151], v[150:151], v[34:35]
    v_pk_add_f32 v[32:33], v[32:33], v[34:35]
    v_add_f32 v52, v32, v33
    v_mul_f32 v46, 0x3b2aaaab, v46
    v_pk_add_f32 v[152:153], v[152:153], v[46:47] op_sel_hi:[1,0] neg_lo:[0,1] neg_hi:[0,1]
    v_pk_add_f32 v[154:155], v[154:155], v[46:47] op_sel_hi:[1,0] neg_lo:[0,1] neg_hi:[0,1]
    v_pk_add_f32 v[156:157], v[156:157], v[46:47] op_sel_hi:[1,0] neg_lo:[0,1] neg_hi:[0,1]
    v_pk_add_f32 v[158:159], v[158:159], v[46:47] op_sel_hi:[1,0] neg_lo:[0,1] neg_hi:[0,1]
    v_pk_add_f32 v[160:161], v[160:161], v[46:47] op_sel_hi:[1,0] neg_lo:[0,1] neg_hi:[0,1]
    v_pk_add_f32 v[162:163], v[162:163], v[46:47] op_sel_hi:[1,0] neg_lo:[0,1] neg_hi:[0,1]
    v_pk_add_f32 v[164:165], v[164:165], v[46:47] op_sel_hi:[1,0] neg_lo:[0,1] neg_hi:[0,1]
    v_pk_add_f32 v[166:167], v[166:167], v[46:47] op_sel_hi:[1,0] neg_lo:[0,1] neg_hi:[0,1]
    v_pk_add_f32 v[168:169], v[168:169], v[46:47] op_sel_hi:[1,0] neg_lo:[0,1] neg_hi:[0,1]
    v_pk_add_f32 v[170:171], v[170:171], v[46:47] op_sel_hi:[1,0] neg_lo:[0,1] neg_hi:[0,1]
    v_pk_add_f32 v[172:173], v[172:173], v[46:47] op_sel_hi:[1,0] neg_lo:[0,1] neg_hi:[0,1]
    v_pk_add_f32 v[174:175], v[174:175], v[46:47] op_sel_hi:[1,0] neg_lo:[0,1] neg_hi:[0,1]
    v_pk_mul_f32 v[32:33], v[152:153], v[152:153]
    v_pk_mul_f32 v[34:35], v[154:155], v[154:155]
    v_pk_fma_f32 v[32:33], v[156:157], v[156:157], v[32:33]
    v_pk_fma_f32 v[34:35], v[158:159], v[158:159], v[34:35]
    v_pk_fma_f32 v[32:33], v[160:161], v[160:161], v[32:33]
    v_pk_fma_f32 v[34:35], v[162:163], v[162:163], v[34:35]
    v_pk_fma_f32 v[32:33], v[164:165], v[164:165], v[32:33]
    v_pk_fma_f32 v[34:35], v[166:167], v[166:167], v[34:35]
    v_pk_fma_f32 v[32:33], v[168:169], v[168:169], v[32:33]
    v_pk_fma_f32 v[34:35], v[170:171], v[170:171], v[34:35]
    v_pk_fma_f32 v[32:33], v[172:173], v[172:173], v[32:33]
    v_pk_fma_f32 v[34:35], v[174:175], v[174:175], v[34:35]
    v_pk_add_f32 v[32:33], v[32:33], v[34:35]
    v_add_f32 v54, v32, v33
    s_nop 0
    v_add_f32_dpp v48, v48, v48 row_ror:8 row_mask:0xf bank_mask:0xf
    v_add_f32_dpp v50, v50, v50 row_ror:8 row_mask:0xf bank_mask:0xf
    v_add_f32_dpp v52, v52, v52 row_ror:8 row_mask:0xf bank_mask:0xf
    v_add_f32_dpp v54, v54, v54 row_ror:8 row_mask:0xf bank_mask:0xf
    v_add_f32_dpp v48, v48, v48 row_ror:4 row_mask:0xf bank_mask:0xf
    v_add_f32_dpp v50, v50, v50 row_ror:4 row_mask:0xf bank_mask:0xf
    v_add_f32_dpp v52, v52, v52 row_ror:4 row_mask:0xf bank_mask:0xf
    v_add_f32_dpp v54, v54, v54 row_ror:4 row_mask:0xf bank_mask:0xf
    v_add_f32_dpp v48, v48, v48 row_ror:2 row_mask:0xf bank_mask:0xf
    v_add_f32_dpp v50, v50, v50 row_ror:2 row_mask:0xf bank_mask:0xf
    v_add_f32_dpp v52, v52, v52 row_ror:2 row_mask:0xf bank_mask:0xf
    v_add_f32_dpp v54, v54, v54 row_ror:2 row_mask:0xf bank_mask:0xf
    v_add_f32_dpp v48, v48, v48 row_ror:1 row_mask:0xf bank_mask:0xf
    v_add_f32_dpp v50, v50, v50 row_ror:1 row_mask:0xf bank_mask:0xf
    v_add_f32_dpp v52, v52, v52 row_ror:1 row_mask:0xf bank_mask:0xf
    v_add_f32_dpp v54, v54, v54 row_ror:1 row_mask:0xf bank_mask:0xf
    v_mov_b32 v49, 0x3727c5ac
    v_fmac_f32 v49, 0x3b2aaaab, v48
    v_rsq_f32 v48, v49
    v_mov_b32 v51, 0x3727c5ac
    v_fmac_f32 v51, 0x3b2aaaab, v50
    v_rsq_f32 v50, v51
    v_mov_b32 v53, 0x3727c5ac
    v_fmac_f32 v53, 0x3b2aaaab, v52
    v_rsq_f32 v52, v53
    v_mov_b32 v55, 0x3727c5ac
    v_fmac_f32 v55, 0x3b2aaaab, v54
    v_rsq_f32 v54, v55
    s_nop 0
    v_pk_mul_f32 v[80:81], v[80:81], v[48:49] op_sel_hi:[1,0]
    v_pk_mul_f32 v[82:83], v[82:83], v[48:49] op_sel_hi:[1,0]
    v_pk_mul_f32 v[84:85], v[84:85], v[48:49] op_sel_hi:[1,0]
    v_pk_mul_f32 v[86:87], v[86:87], v[48:49] op_sel_hi:[1,0]
    v_pk_mul_f32 v[88:89], v[88:89], v[48:49] op_sel_hi:[1,0]
    v_pk_mul_f32 v[90:91], v[90:91], v[48:49] op_sel_hi:[1,0]
    v_pk_mul_f32 v[92:93], v[92:93], v[48:49] op_sel_hi:[1,0]
    v_pk_mul_f32 v[94:95], v[94:95], v[48:49] op_sel_hi:[1,0]
    v_pk_mul_f32 v[96:97], v[96:97], v[48:49] op_sel_hi:[1,0]
    v_pk_mul_f32 v[98:99], v[98:99], v[48:49] op_sel_hi:[1,0]
    v_pk_mul_f32 v[100:101], v[100:101], v[48:49] op_sel_hi:[1,0]
    v_pk_mul_f32 v[102:103], v[102:103], v[48:49] op_sel_hi:[1,0]
    v_pk_mul_f32 v[104:105], v[104:105], v[50:51] op_sel_hi:[1,0]
    v_pk_mul_f32 v[106:107], v[106:107], v[50:51] op_sel_hi:[1,0]
    v_pk_mul_f32 v[108:109], v[108:109], v[50:51] op_sel_hi:[1,0]
    v_pk_mul_f32 v[110:111], v[110:111], v[50:51] op_sel_hi:[1,0]
    v_pk_mul_f32 v[112:113], v[112:113], v[50:51] op_sel_hi:[1,0]
    v_pk_mul_f32 v[114:115], v[114:115], v[50:51] op_sel_hi:[1,0]
    v_pk_mul_f32 v[116:117], v[116:117], v[50:51] op_sel_hi:[1,0]
    v_pk_mul_f32 v[118:119], v[118:119], v[50:51] op_sel_hi:[1,0]
    v_pk_mul_f32 v[120:121], v[120:121], v[50:51] op_sel_hi:[1,0]
    v_pk_mul_f32 v[122:123], v[122:123], v[50:51] op_sel_hi:[1,0]
    v_pk_mul_f32 v[124:125], v[124:125], v[50:51] op_sel_hi:[1,0]
    v_pk_mul_f32 v[126:127], v[126:127], v[50:51] op_sel_hi:[1,0]
    v_pk_mul_f32 v[128:129], v[128:129], v[52:53] op_sel_hi:[1,0]
    v_pk_mul_f32 v[130:131], v[130:131], v[52:53] op_sel_hi:[1,0]
    v_pk_mul_f32 v[132:133], v[132:133], v[52:53] op_sel_hi:[1,0]
    v_pk_mul_f32 v[134:135], v[134:135], v[52:53] op_sel_hi:[1,0]
    v_pk_mul_f32 v[136:137], v[136:137], v[52:53] op_sel_hi:[1,0]
    v_pk_mul_f32 v[138:139], v[138:139], v[52:53] op_sel_hi:[1,0]
    v_pk_mul_f32 v[140:141], v[140:141], v[52:53] op_sel_hi:[1,0]
    v_pk_mul_f32 v[142:143], v[142:143], v[52:53] op_sel_hi:[1,0]
    v_pk_mul_f32 v[144:145], v[144:145], v[52:53] op_sel_hi:[1,0]
    v_pk_mul_f32 v[146:147], v[146:147], v[52:53] op_sel_hi:[1,0]
    v_pk_mul_f32 v[148:149], v[148:149], v[52:53] op_sel_hi:[1,0]
    v_pk_mul_f32 v[150:151], v[150:151], v[52:53] op_sel_hi:[1,0]
    v_pk_mul_f32 v[152:153], v[152:153], v[54:55] op_sel_hi:[1,0]
    v_pk_mul_f32 v[154:155], v[154:155], v[54:55] op_sel_hi:[1,0]
    v_pk_mul_f32 v[156:157], v[156:157], v[54:55] op_sel_hi:[1,0]
    v_pk_mul_f32 v[158:159], v[158:159], v[54:55] op_sel_hi:[1,0]
    v_pk_mul_f32 v[160:161], v[160:161], v[54:55] op_sel_hi:[1,0]
    v_pk_mul_f32 v[162:163], v[162:163], v[54:55] op_sel_hi:[1,0]
    v_pk_mul_f32 v[164:165], v[164:165], v[54:55] op_sel_hi:[1,0]
    v_pk_mul_f32 v[166:167], v[166:167], v[54:55] op_sel_hi:[1,0]
    v_pk_mul_f32 v[168:169], v[168:169], v[54:55] op_sel_hi:[1,0]
    v_pk_mul_f32 v[170:171], v[170:171], v[54:55] op_sel_hi:[1,0]
    v_pk_mul_f32 v[172:173], v[172:173], v[54:55] op_sel_hi:[1,0]
    v_pk_mul_f32 v[174:175], v[174:175], v[54:55] op_sel_hi:[1,0]
    s_cmp_lg_u32 s57, 2
    s_cbranch_scc1 P1_NOXF
    s_and_b32 s11, s5, 1
    s_mul_i32 s11, s11, 24576
    s_lshl_b32 s12, s3, 10
    s_add_u32 s11, s11, s12
    s_mul_i32 s10, s4, 49152
    s_add_u32 s10, s10, s11
    s_add_u32 s10, s10, 1048576
    s_lshl_b32 s12, s3, 5
    v_xor_b32 v36, s12, v240
    v_add_u32 v36, s11, v36
    v_cvt_pk_bf16_f32 v176, v80, v81
    v_cvt_pk_bf16_f32 v177, v82, v83
    v_cvt_pk_bf16_f32 v178, v84, v85
    v_cvt_pk_bf16_f32 v179, v86, v87
    ds_write_b128 v8, v[176:179] offset:4096
    v_cvt_pk_bf16_f32 v180, v104, v105
    v_cvt_pk_bf16_f32 v181, v106, v107
    v_cvt_pk_bf16_f32 v182, v108, v109
    v_cvt_pk_bf16_f32 v183, v110, v111
    ds_write_b128 v2, v[180:183] offset:4096
    v_cvt_pk_bf16_f32 v184, v128, v129
    v_cvt_pk_bf16_f32 v185, v130, v131
    v_cvt_pk_bf16_f32 v186, v132, v133
    v_cvt_pk_bf16_f32 v187, v134, v135
    ds_write_b128 v8, v[184:187] offset:4224
    v_cvt_pk_bf16_f32 v188, v152, v153
    v_cvt_pk_bf16_f32 v189, v154, v155
    v_cvt_pk_bf16_f32 v190, v156, v157
    v_cvt_pk_bf16_f32 v191, v158, v159
    ds_write_b128 v2, v[188:191] offset:4224
    v_cvt_pk_bf16_f32 v192, v88, v89
    v_cvt_pk_bf16_f32 v193, v90, v91
    v_cvt_pk_bf16_f32 v194, v92, v93
    v_cvt_pk_bf16_f32 v195, v94, v95
    ds_write_b128 v8, v[192:195] offset:12288
    v_cvt_pk_bf16_f32 v196, v112, v113
    v_cvt_pk_bf16_f32 v197, v114, v115
    v_cvt_pk_bf16_f32 v198, v116, v117
    v_cvt_pk_bf16_f32 v199, v118, v119
    ds_write_b128 v2, v[196:199] offset:12288
    v_cvt_pk_bf16_f32 v200, v136, v137
    v_cvt_pk_bf16_f32 v201, v138, v139
    v_cvt_pk_bf16_f32 v202, v140, v141
    v_cvt_pk_bf16_f32 v203, v142, v143
    ds_write_b128 v8, v[200:203] offset:12416
    v_cvt_pk_bf16_f32 v204, v160, v161
    v_cvt_pk_bf16_f32 v205, v162, v163
    v_cvt_pk_bf16_f32 v206, v164, v165
    v_cvt_pk_bf16_f32 v207, v166, v167
    ds_write_b128 v2, v[204:207] offset:12416
    v_cvt_pk_bf16_f32 v208, v96, v97
    v_cvt_pk_bf16_f32 v209, v98, v99
    v_cvt_pk_bf16_f32 v210, v100, v101
    v_cvt_pk_bf16_f32 v211, v102, v103
    ds_write_b128 v8, v[208:211] offset:20480
    v_cvt_pk_bf16_f32 v212, v120, v121
    v_cvt_pk_bf16_f32 v213, v122, v123
    v_cvt_pk_bf16_f32 v214, v124, v125
    v_cvt_pk_bf16_f32 v215, v126, v127
    ds_write_b128 v2, v[212:215] offset:20480
    v_cvt_pk_bf16_f32 v216, v144, v145
    v_cvt_pk_bf16_f32 v217, v146, v147
    v_cvt_pk_bf16_f32 v218, v148, v149
    v_cvt_pk_bf16_f32 v219, v150, v151
    ds_write_b128 v8, v[216:219] offset:20608
    v_cvt_pk_bf16_f32 v220, v168, v169
    v_cvt_pk_bf16_f32 v221, v170, v171
    v_cvt_pk_bf16_f32 v222, v172, v173
    v_cvt_pk_bf16_f32 v223, v174, v175
    ds_write_b128 v2, v[220:223] offset:20608
    s_waitcnt lgkmcnt(0)
    s_barrier
    ds_read_b128 v[176:179], v36 offset:4096
    ds_read_b128 v[180:183], v36 offset:8192
    ds_read_b128 v[184:187], v36 offset:12288
    ds_read_b128 v[188:191], v36 offset:16384
    ds_read_b128 v[192:195], v36 offset:20480
    ds_read_b128 v[196:199], v36 offset:24576
    s_waitcnt lgkmcnt(5)
    buffer_store_dwordx4 v[176:179], v5, s[40:43], s10 offen sc1
    s_add_u32 s10, s10, 4096
    s_waitcnt lgkmcnt(4)
    buffer_store_dwordx4 v[180:183], v5, s[40:43], s10 offen sc1
    s_add_u32 s10, s10, 4096
    s_waitcnt lgkmcnt(3)
    buffer_store_dwordx4 v[184:187], v5, s[40:43], s10 offen sc1
    s_add_u32 s10, s10, 4096
    s_waitcnt lgkmcnt(2)
    buffer_store_dwordx4 v[188:191], v5, s[40:43], s10 offen sc1
    s_add_u32 s10, s10, 4096
    s_waitcnt lgkmcnt(1)
    buffer_store_dwordx4 v[192:195], v5, s[40:43], s10 offen sc1
    s_add_u32 s10, s10, 4096
    s_waitcnt lgkmcnt(0)
    buffer_store_dwordx4 v[196:199], v5, s[40:43], s10 offen sc1
    s_waitcnt vmcnt(0)
    s_barrier
    s_cmp_lg_u32 s3, 0
    s_cbranch_scc1 FX_SKIP
    s_cmp_eq_u32 s70, 1
    s_cbranch_scc1 FX_NOK
    s_mov_b32 s58, 0
    s_waitcnt vmcnt(0)
FX_NCHK:
    v_readfirstlane_b32 s68, v244
    v_readfirstlane_b32 s69, v245
    s_add_u32 s58, s58, 1
    s_cmp_gt_u32 s58, 100000
    s_cbranch_scc1 FX_NSET
    s_cmp_lg_u32 s68, 0
    s_cbranch_scc1 FX_NSET
    buffer_load_dwordx2 v[244:245], v15, s[52:55], 0 offen sc1
    s_waitcnt vmcnt(0)
    s_branch FX_NCHK
FX_NSET:
    s_mov_b32 s70, 1
FX_NOK:
    v_mov_b32 v34, s68
    v_mov_b32 v35, s69
    s_mov_b64 exec, 1
    buffer_store_dwordx2 v[34:35], v15, s[40:43], s14 offen sc0 sc1
    s_mov_b64 exec, -1
    s_nop 1
FX_SKIP:
P1_NOXF:
    s_and_b32 s10, s5, 3
    s_mul_i32 s10, s10, 3
    s_lshr_b32 s10, s10, 1
    s_lshr_b32 s11, s5, 2
    s_mul_i32 s11, s11, 6
    s_add_u32 s10, s10, s11
    s_mul_i32 s10, s10, 12
    s_lshl_b32 s10, s10, 6
    s_add_u32 s10, s10, 10485760
    v_lshlrev_b32 v32, 6, v1
    v_add_u32 v33, s10, v32
    v_add_u32 v34, 10493440, v32
    v_cmp_lt_u32 vcc, 23, v1
    s_lshl_b32 s10, s6, 3
    s_add_u32 s10, s10, s63
    v_cndmask_b32 v33, v33, v34, vcc
    s_lshl_b32 s10, s10, 8
    s_add_u32 s10, s10, 10496128
    v_and_b32 v34, 192, v32
    v_add_u32 v246, s10, v34
    v_cmp_lt_u32 vcc, 41, v1
    v_mov_b32 v35, 10494976
    s_mul_i32 s7, s6, 4608
    s_mul_i32 s10, s5, 3
    v_cndmask_b32 v33, v33, v35, vcc
    s_add_u32 s10, s10, s3
    s_mul_i32 s11, s10, 24576
    s_add_u32 s11, s11, 16384
    s_cmp_lg_u32 s3, 0
    s_cbranch_scc1 H1_SKIP
    s_cmp_eq_u32 s70, 1
    s_cbranch_scc1 H1_NOK
    s_mov_b32 s58, 0
    s_waitcnt vmcnt(0)
H1_NCHK:
    v_readfirstlane_b32 s68, v244
    v_readfirstlane_b32 s69, v245
    s_add_u32 s58, s58, 1
    s_cmp_gt_u32 s58, 100000
    s_cbranch_scc1 H1_NSET
    s_cmp_lg_u32 s68, 0
    s_cbranch_scc1 H1_NSET
    buffer_load_dwordx2 v[244:245], v15, s[52:55], 0 offen sc1
    s_waitcnt vmcnt(0)
    s_branch H1_NCHK
H1_NSET:
    s_mov_b32 s70, 1
H1_NOK:
    s_mov_b32 s58, 0
H1_POLL:
    buffer_load_dwordx2 v[36:37], v33, s[40:43], 0 offen sc1
    s_add_u32 s58, s58, 1
    s_waitcnt vmcnt(0)
    v_cmp_ne_u32 vcc, s68, v36
    v_cmp_ne_u32 s[56:57], s69, v37
    s_cmp_gt_u32 s58, 100000
    s_cbranch_scc1 H1_DONE
    s_or_b64 vcc, vcc, s[56:57]
    s_cbranch_vccz H1_DONE
    s_sleep 1
    s_branch H1_POLL
H1_DONE:
H1_SKIP:
    s_barrier
    s_mov_b32 s48, s26
    s_and_b32 s49, s27, 0xffff
    s_mov_b32 s50, 1572864
    s_mov_b32 s51, 0x20000
    buffer_load_dwordx4 v[12:15], v6, s[40:43], s7 offen sc1
    s_cmp_eq_u32 s3, 3
    s_cbranch_scc1 F2_W3
    buffer_load_dwordx2 v[244:245], v246, s[40:43], 0 offen sc1
    buffer_load_dwordx4 a[0:3], v5, s[40:43], s11 offen offset:0 sc1
    buffer_load_dwordx4 a[4:7], v5, s[40:43], s11 offen offset:1024 sc1
    buffer_load_dwordx4 a[8:11], v5, s[40:43], s11 offen offset:2048 sc1
    buffer_load_dwordx4 a[12:15], v5, s[40:43], s11 offen offset:3072 sc1
    s_add_u32 s11, s11, 4096
    buffer_load_dwordx4 a[16:19], v5, s[40:43], s11 offen offset:0 sc1
    buffer_load_dwordx4 a[20:23], v5, s[40:43], s11 offen offset:1024 sc1
    buffer_load_dwordx4 a[24:27], v5, s[40:43], s11 offen offset:2048 sc1
    buffer_load_dwordx4 a[28:31], v5, s[40:43], s11 offen offset:3072 sc1
    s_add_u32 s11, s11, 4096
    buffer_load_dwordx4 a[32:35], v5, s[40:43], s11 offen offset:0 sc1
    buffer_load_dwordx4 a[36:39], v5, s[40:43], s11 offen offset:1024 sc1
    buffer_load_dwordx4 a[40:43], v5, s[40:43], s11 offen offset:2048 sc1
    buffer_load_dwordx4 a[44:47], v5, s[40:43], s11 offen offset:3072 sc1
    s_add_u32 s11, s11, 4096
    s_waitcnt vmcnt(13)
    ds_write_b128 v6, v[12:15] offset:0
    s_waitcnt lgkmcnt(0)
    s_barrier
    ds_read_b128 v[16:19], v7 offset:0
    ds_read_b128 v[20:23], v7 offset:16
    ds_read_b128 v[24:27], v7 offset:1536
    ds_read_b128 v[28:31], v7 offset:1552
    ds_read_b128 v[32:35], v7 offset:512
    ds_read_b128 v[36:39], v7 offset:528
    ds_read_b128 v[40:43], v7 offset:2048
    ds_read_b128 v[44:47], v7 offset:2064
    ds_read_b128 v[48:51], v7 offset:1024
    ds_read_b128 v[52:55], v7 offset:1040
    ds_read_b128 v[56:59], v7 offset:2560
    ds_read_b128 v[60:63], v7 offset:2576
    s_waitcnt lgkmcnt(8)
    v_pk_fma_f32 v[80:81], v[80:81], v[24:25], v[16:17]
    v_pk_fma_f32 v[82:83], v[82:83], v[26:27], v[18:19]
    v_pk_fma_f32 v[84:85], v[84:85], v[28:29], v[20:21]
    v_pk_fma_f32 v[86:87], v[86:87], v[30:31], v[22:23]
    v_cvt_pk_bf16_f32 v64, v80, v81
    v_cvt_pk_bf16_f32 v65, v82, v83
    v_cvt_pk_bf16_f32 v66, v84, v85
    v_cvt_pk_bf16_f32 v67, v86, v87
    ds_write_b128 v8, v[64:67] offset:4096
    buffer_load_dwordx4 a[48:51], v5, s[40:43], s11 offen offset:0 sc1
    v_pk_fma_f32 v[104:105], v[104:105], v[24:25], v[16:17]
    v_pk_fma_f32 v[106:107], v[106:107], v[26:27], v[18:19]
    v_pk_fma_f32 v[108:109], v[108:109], v[28:29], v[20:21]
    v_pk_fma_f32 v[110:111], v[110:111], v[30:31], v[22:23]
    v_cvt_pk_bf16_f32 v68, v104, v105
    v_cvt_pk_bf16_f32 v69, v106, v107
    v_cvt_pk_bf16_f32 v70, v108, v109
    v_cvt_pk_bf16_f32 v71, v110, v111
    ds_write_b128 v2, v[68:71] offset:4096
    buffer_load_dwordx4 a[52:55], v5, s[40:43], s11 offen offset:1024 sc1
    v_pk_fma_f32 v[128:129], v[128:129], v[24:25], v[16:17]
    v_pk_fma_f32 v[130:131], v[130:131], v[26:27], v[18:19]
    v_pk_fma_f32 v[132:133], v[132:133], v[28:29], v[20:21]
    v_pk_fma_f32 v[134:135], v[134:135], v[30:31], v[22:23]
    v_cvt_pk_bf16_f32 v72, v128, v129
    v_cvt_pk_bf16_f32 v73, v130, v131
    v_cvt_pk_bf16_f32 v74, v132, v133
    v_cvt_pk_bf16_f32 v75, v134, v135
    ds_write_b128 v8, v[72:75] offset:4224
    buffer_load_dwordx4 a[56:59], v5, s[40:43], s11 offen offset:2048 sc1
    v_pk_fma_f32 v[152:153], v[152:153], v[24:25], v[16:17]
    v_pk_fma_f32 v[154:155], v[154:155], v[26:27], v[18:19]
    v_pk_fma_f32 v[156:157], v[156:157], v[28:29], v[20:21]
    v_pk_fma_f32 v[158:159], v[158:159], v[30:31], v[22:23]
    v_cvt_pk_bf16_f32 v76, v152, v153
    v_cvt_pk_bf16_f32 v77, v154, v155
    v_cvt_pk_bf16_f32 v78, v156, v157
    v_cvt_pk_bf16_f32 v79, v158, v159
    ds_write_b128 v2, v[76:79] offset:4224
    buffer_load_dwordx4 a[60:63], v5, s[40:43], s11 offen offset:3072 sc1
    s_add_u32 s11, s11, 4096
    s_waitcnt lgkmcnt(8)
    v_pk_fma_f32 v[88:89], v[88:89], v[40:41], v[32:33]
    v_pk_fma_f32 v[90:91], v[90:91], v[42:43], v[34:35]
    v_pk_fma_f32 v[92:93], v[92:93], v[44:45], v[36:37]
    v_pk_fma_f32 v[94:95], v[94:95], v[46:47], v[38:39]
    v_cvt_pk_bf16_f32 v64, v88, v89
    v_cvt_pk_bf16_f32 v65, v90, v91
    v_cvt_pk_bf16_f32 v66, v92, v93
    v_cvt_pk_bf16_f32 v67, v94, v95
    ds_write_b128 v8, v[64:67] offset:12288
    buffer_load_dwordx4 a[64:67], v5, s[40:43], s11 offen offset:0 sc1
    v_pk_fma_f32 v[112:113], v[112:113], v[40:41], v[32:33]
    v_pk_fma_f32 v[114:115], v[114:115], v[42:43], v[34:35]
    v_pk_fma_f32 v[116:117], v[116:117], v[44:45], v[36:37]
    v_pk_fma_f32 v[118:119], v[118:119], v[46:47], v[38:39]
    v_cvt_pk_bf16_f32 v68, v112, v113
    v_cvt_pk_bf16_f32 v69, v114, v115
    v_cvt_pk_bf16_f32 v70, v116, v117
    v_cvt_pk_bf16_f32 v71, v118, v119
    ds_write_b128 v2, v[68:71] offset:12288
    buffer_load_dwordx4 a[68:71], v5, s[40:43], s11 offen offset:1024 sc1
    v_pk_fma_f32 v[136:137], v[136:137], v[40:41], v[32:33]
    v_pk_fma_f32 v[138:139], v[138:139], v[42:43], v[34:35]
    v_pk_fma_f32 v[140:141], v[140:141], v[44:45], v[36:37]
    v_pk_fma_f32 v[142:143], v[142:143], v[46:47], v[38:39]
    v_cvt_pk_bf16_f32 v72, v136, v137
    v_cvt_pk_bf16_f32 v73, v138, v139
    v_cvt_pk_bf16_f32 v74, v140, v141
    v_cvt_pk_bf16_f32 v75, v142, v143
    ds_write_b128 v8, v[72:75] offset:12416
    buffer_load_dwordx4 a[72:75], v5, s[40:43], s11 offen offset:2048 sc1
    v_pk_fma_f32 v[160:161], v[160:161], v[40:41], v[32:33]
    v_pk_fma_f32 v[162:163], v[162:163], v[42:43], v[34:35]
    v_pk_fma_f32 v[164:165], v[164:165], v[44:45], v[36:37]
    v_pk_fma_f32 v[166:167], v[166:167], v[46:47], v[38:39]
    v_cvt_pk_bf16_f32 v76, v160, v161
    v_cvt_pk_bf16_f32 v77, v162, v163
    v_cvt_pk_bf16_f32 v78, v164, v165
    v_cvt_pk_bf16_f32 v79, v166, v167
    ds_write_b128 v2, v[76:79] offset:12416
    buffer_load_dwordx4 a[76:79], v5, s[40:43], s11 offen offset:3072 sc1
    s_add_u32 s11, s11, 4096
    s_waitcnt lgkmcnt(8)
    v_pk_fma_f32 v[96:97], v[96:97], v[56:57], v[48:49]
    v_pk_fma_f32 v[98:99], v[98:99], v[58:59], v[50:51]
    v_pk_fma_f32 v[100:101], v[100:101], v[60:61], v[52:53]
    v_pk_fma_f32 v[102:103], v[102:103], v[62:63], v[54:55]
    v_cvt_pk_bf16_f32 v64, v96, v97
    v_cvt_pk_bf16_f32 v65, v98, v99
    v_cvt_pk_bf16_f32 v66, v100, v101
    v_cvt_pk_bf16_f32 v67, v102, v103
    ds_write_b128 v8, v[64:67] offset:20480
    buffer_load_dwordx4 a[80:83], v5, s[40:43], s11 offen offset:0 sc1
    v_pk_fma_f32 v[120:121], v[120:121], v[56:57], v[48:49]
    v_pk_fma_f32 v[122:123], v[122:123], v[58:59], v[50:51]
    v_pk_fma_f32 v[124:125], v[124:125], v[60:61], v[52:53]
    v_pk_fma_f32 v[126:127], v[126:127], v[62:63], v[54:55]
    v_cvt_pk_bf16_f32 v68, v120, v121
    v_cvt_pk_bf16_f32 v69, v122, v123
    v_cvt_pk_bf16_f32 v70, v124, v125
    v_cvt_pk_bf16_f32 v71, v126, v127
    ds_write_b128 v2, v[68:71] offset:20480
    buffer_load_dwordx4 a[84:87], v5, s[40:43], s11 offen offset:1024 sc1
    v_pk_fma_f32 v[144:145], v[144:145], v[56:57], v[48:49]
    v_pk_fma_f32 v[146:147], v[146:147], v[58:59], v[50:51]
    v_pk_fma_f32 v[148:149], v[148:149], v[60:61], v[52:53]
    v_pk_fma_f32 v[150:151], v[150:151], v[62:63], v[54:55]
    v_cvt_pk_bf16_f32 v72, v144, v145
    v_cvt_pk_bf16_f32 v73, v146, v147
    v_cvt_pk_bf16_f32 v74, v148, v149
    v_cvt_pk_bf16_f32 v75, v150, v151
    ds_write_b128 v8, v[72:75] offset:20608
    buffer_load_dwordx4 a[88:91], v5, s[40:43], s11 offen offset:2048 sc1
    v_pk_fma_f32 v[168:169], v[168:169], v[56:57], v[48:49]
    v_pk_fma_f32 v[170:171], v[170:171], v[58:59], v[50:51]
    v_pk_fma_f32 v[172:173], v[172:173], v[60:61], v[52:53]
    v_pk_fma_f32 v[174:175], v[174:175], v[62:63], v[54:55]
    v_cvt_pk_bf16_f32 v76, v168, v169
    v_cvt_pk_bf16_f32 v77, v170, v171
    v_cvt_pk_bf16_f32 v78, v172, v173
    v_cvt_pk_bf16_f32 v79, v174, v175
    ds_write_b128 v2, v[76:79] offset:20608
    buffer_load_dwordx4 a[92:95], v5, s[40:43], s11 offen offset:3072 sc1
    s_cmp_lg_u32 s3, 0
    s_cbranch_scc1 FXC_SKIP
    s_waitcnt vmcnt(24)
    v_cmp_ne_u32 vcc, s68, v244
    v_cmp_ne_u32 s[56:57], s69, v245
    s_nop 1
    s_or_b64 vcc, vcc, s[56:57]
    s_cbranch_vccz FXC_SKIP
    s_mov_b32 s58, 0
FXC_POLL:
    buffer_load_dwordx2 v[244:245], v246, s[40:43], 0 offen sc1
    s_add_u32 s58, s58, 1
    s_waitcnt vmcnt(0)
    v_cmp_ne_u32 vcc, s68, v244
    v_cmp_ne_u32 s[56:57], s69, v245
    s_cmp_gt_u32 s58, 100000
    s_cbranch_scc1 FXC_DONE
    s_or_b64 vcc, vcc, s[56:57]
    s_cbranch_vccz FXC_DONE
    s_sleep 1
    s_branch FXC_POLL
FXC_DONE:
FXC_SKIP:
    s_waitcnt lgkmcnt(0)
    s_barrier
    s_branch F2_MM
F2_W3:
    s_waitcnt vmcnt(0)
    ds_write_b128 v6, v[12:15] offset:0
    s_waitcnt lgkmcnt(0)
    s_barrier
    ds_read_b128 v[16:19], v7 offset:0
    ds_read_b128 v[20:23], v7 offset:16
    ds_read_b128 v[24:27], v7 offset:1536
    ds_read_b128 v[28:31], v7 offset:1552
    ds_read_b128 v[32:35], v7 offset:512
    ds_read_b128 v[36:39], v7 offset:528
    ds_read_b128 v[40:43], v7 offset:2048
    ds_read_b128 v[44:47], v7 offset:2064
    ds_read_b128 v[48:51], v7 offset:1024
    ds_read_b128 v[52:55], v7 offset:1040
    ds_read_b128 v[56:59], v7 offset:2560
    ds_read_b128 v[60:63], v7 offset:2576
    s_waitcnt lgkmcnt(8)
    v_pk_fma_f32 v[80:81], v[80:81], v[24:25], v[16:17]
    v_pk_fma_f32 v[82:83], v[82:83], v[26:27], v[18:19]
    v_pk_fma_f32 v[84:85], v[84:85], v[28:29], v[20:21]
    v_pk_fma_f32 v[86:87], v[86:87], v[30:31], v[22:23]
    v_cvt_pk_bf16_f32 v64, v80, v81
    v_cvt_pk_bf16_f32 v65, v82, v83
    v_cvt_pk_bf16_f32 v66, v84, v85
    v_cvt_pk_bf16_f32 v67, v86, v87
    ds_write_b128 v8, v[64:67] offset:4096
    v_pk_fma_f32 v[104:105], v[104:105], v[24:25], v[16:17]
    v_pk_fma_f32 v[106:107], v[106:107], v[26:27], v[18:19]
    v_pk_fma_f32 v[108:109], v[108:109], v[28:29], v[20:21]
    v_pk_fma_f32 v[110:111], v[110:111], v[30:31], v[22:23]
    v_cvt_pk_bf16_f32 v68, v104, v105
    v_cvt_pk_bf16_f32 v69, v106, v107
    v_cvt_pk_bf16_f32 v70, v108, v109
    v_cvt_pk_bf16_f32 v71, v110, v111
    ds_write_b128 v2, v[68:71] offset:4096
    v_pk_fma_f32 v[128:129], v[128:129], v[24:25], v[16:17]
    v_pk_fma_f32 v[130:131], v[130:131], v[26:27], v[18:19]
    v_pk_fma_f32 v[132:133], v[132:133], v[28:29], v[20:21]
    v_pk_fma_f32 v[134:135], v[134:135], v[30:31], v[22:23]
    v_cvt_pk_bf16_f32 v72, v128, v129
    v_cvt_pk_bf16_f32 v73, v130, v131
    v_cvt_pk_bf16_f32 v74, v132, v133
    v_cvt_pk_bf16_f32 v75, v134, v135
    ds_write_b128 v8, v[72:75] offset:4224
    v_pk_fma_f32 v[152:153], v[152:153], v[24:25], v[16:17]
    v_pk_fma_f32 v[154:155], v[154:155], v[26:27], v[18:19]
    v_pk_fma_f32 v[156:157], v[156:157], v[28:29], v[20:21]
    v_pk_fma_f32 v[158:159], v[158:159], v[30:31], v[22:23]
    v_cvt_pk_bf16_f32 v76, v152, v153
    v_cvt_pk_bf16_f32 v77, v154, v155
    v_cvt_pk_bf16_f32 v78, v156, v157
    v_cvt_pk_bf16_f32 v79, v158, v159
    ds_write_b128 v2, v[76:79] offset:4224
    s_waitcnt lgkmcnt(8)
    v_pk_fma_f32 v[88:89], v[88:89], v[40:41], v[32:33]
    v_pk_fma_f32 v[90:91], v[90:91], v[42:43], v[34:35]
    v_pk_fma_f32 v[92:93], v[92:93], v[44:45], v[36:37]
    v_pk_fma_f32 v[94:95], v[94:95], v[46:47], v[38:39]
    v_cvt_pk_bf16_f32 v64, v88, v89
    v_cvt_pk_bf16_f32 v65, v90, v91
    v_cvt_pk_bf16_f32 v66, v92, v93
    v_cvt_pk_bf16_f32 v67, v94, v95
    ds_write_b128 v8, v[64:67] offset:12288
    v_pk_fma_f32 v[112:113], v[112:113], v[40:41], v[32:33]
    v_pk_fma_f32 v[114:115], v[114:115], v[42:43], v[34:35]
    v_pk_fma_f32 v[116:117], v[116:117], v[44:45], v[36:37]
    v_pk_fma_f32 v[118:119], v[118:119], v[46:47], v[38:39]
    v_cvt_pk_bf16_f32 v68, v112, v113
    v_cvt_pk_bf16_f32 v69, v114, v115
    v_cvt_pk_bf16_f32 v70, v116, v117
    v_cvt_pk_bf16_f32 v71, v118, v119
    ds_write_b128 v2, v[68:71] offset:12288
    v_pk_fma_f32 v[136:137], v[136:137], v[40:41], v[32:33]
    v_pk_fma_f32 v[138:139], v[138:139], v[42:43], v[34:35]
    v_pk_fma_f32 v[140:141], v[140:141], v[44:45], v[36:37]
    v_pk_fma_f32 v[142:143], v[142:143], v[46:47], v[38:39]
    v_cvt_pk_bf16_f32 v72, v136, v137
    v_cvt_pk_bf16_f32 v73, v138, v139
    v_cvt_pk_bf16_f32 v74, v140, v141
    v_cvt_pk_bf16_f32 v75, v142, v143
    ds_write_b128 v8, v[72:75] offset:12416
    v_pk_fma_f32 v[160:161], v[160:161], v[40:41], v[32:33]
    v_pk_fma_f32 v[162:163], v[162:163], v[42:43], v[34:35]
    v_pk_fma_f32 v[164:165], v[164:165], v[44:45], v[36:37]
    v_pk_fma_f32 v[166:167], v[166:167], v[46:47], v[38:39]
    v_cvt_pk_bf16_f32 v76, v160, v161
    v_cvt_pk_bf16_f32 v77, v162, v163
    v_cvt_pk_bf16_f32 v78, v164, v165
    v_cvt_pk_bf16_f32 v79, v166, v167
    ds_write_b128 v2, v[76:79] offset:12416
    s_waitcnt lgkmcnt(8)
    v_pk_fma_f32 v[96:97], v[96:97], v[56:57], v[48:49]
    v_pk_fma_f32 v[98:99], v[98:99], v[58:59], v[50:51]
    v_pk_fma_f32 v[100:101], v[100:101], v[60:61], v[52:53]
    v_pk_fma_f32 v[102:103], v[102:103], v[62:63], v[54:55]
    v_cvt_pk_bf16_f32 v64, v96, v97
    v_cvt_pk_bf16_f32 v65, v98, v99
    v_cvt_pk_bf16_f32 v66, v100, v101
    v_cvt_pk_bf16_f32 v67, v102, v103
    ds_write_b128 v8, v[64:67] offset:20480
    v_pk_fma_f32 v[120:121], v[120:121], v[56:57], v[48:49]
    v_pk_fma_f32 v[122:123], v[122:123], v[58:59], v[50:51]
    v_pk_fma_f32 v[124:125], v[124:125], v[60:61], v[52:53]
    v_pk_fma_f32 v[126:127], v[126:127], v[62:63], v[54:55]
    v_cvt_pk_bf16_f32 v68, v120, v121
    v_cvt_pk_bf16_f32 v69, v122, v123
    v_cvt_pk_bf16_f32 v70, v124, v125
    v_cvt_pk_bf16_f32 v71, v126, v127
    ds_write_b128 v2, v[68:71] offset:20480
    v_pk_fma_f32 v[144:145], v[144:145], v[56:57], v[48:49]
    v_pk_fma_f32 v[146:147], v[146:147], v[58:59], v[50:51]
    v_pk_fma_f32 v[148:149], v[148:149], v[60:61], v[52:53]
    v_pk_fma_f32 v[150:151], v[150:151], v[62:63], v[54:55]
    v_cvt_pk_bf16_f32 v72, v144, v145
    v_cvt_pk_bf16_f32 v73, v146, v147
    v_cvt_pk_bf16_f32 v74, v148, v149
    v_cvt_pk_bf16_f32 v75, v150, v151
    ds_write_b128 v8, v[72:75] offset:20608
    v_pk_fma_f32 v[168:169], v[168:169], v[56:57], v[48:49]
    v_pk_fma_f32 v[170:171], v[170:171], v[58:59], v[50:51]
    v_pk_fma_f32 v[172:173], v[172:173], v[60:61], v[52:53]
    v_pk_fma_f32 v[174:175], v[174:175], v[62:63], v[54:55]
    v_cvt_pk_bf16_f32 v76, v168, v169
    v_cvt_pk_bf16_f32 v77, v170, v171
    v_cvt_pk_bf16_f32 v78, v172, v173
    v_cvt_pk_bf16_f32 v79, v174, v175
    ds_write_b128 v2, v[76:79] offset:20608
    s_waitcnt lgkmcnt(0)
    s_barrier
    s_branch F2_FIN
F2_MM:
    s_cmp_ge_u32 s5, 4
    s_cbranch_scc1 F2_V
    ds_read_b128 v[16:19], v240 offset:4096
    ds_read_b128 v[20:23], v240 offset:28672
    ds_read_b128 v[24:27], v241 offset:5120
    ds_read_b128 v[28:31], v241 offset:29696
    ds_read_b128 v[32:35], v242 offset:6144
    ds_read_b128 v[36:39], v242 offset:30720
    ds_read_b128 v[40:43], v243 offset:7168
    ds_read_b128 v[44:47], v243 offset:31744
    s_waitcnt vmcnt(23) lgkmcnt(6)
    v_mfma_f32_32x32x16_bf16 v[128:143], a[0:3], v[16:19], 0
    v_mfma_f32_32x32x16_bf16 v[144:159], a[0:3], v[20:23], 0
    ds_read_b128 v[16:19], v240 offset:8192
    ds_read_b128 v[20:23], v240 offset:32768
    s_waitcnt vmcnt(22) lgkmcnt(6)
    v_mfma_f32_32x32x16_bf16 v[128:143], a[4:7], v[24:27], v[128:143]
    v_mfma_f32_32x32x16_bf16 v[144:159], a[4:7], v[28:31], v[144:159]
    ds_read_b128 v[24:27], v241 offset:9216
    ds_read_b128 v[28:31], v241 offset:33792
    s_waitcnt vmcnt(21) lgkmcnt(6)
    v_mfma_f32_32x32x16_bf16 v[128:143], a[8:11], v[32:35], v[128:143]
    v_mfma_f32_32x32x16_bf16 v[144:159], a[8:11], v[36:39], v[144:159]
    ds_read_b128 v[32:35], v242 offset:10240
    ds_read_b128 v[36:39], v242 offset:34816
    s_waitcnt vmcnt(20) lgkmcnt(6)
    v_mfma_f32_32x32x16_bf16 v[128:143], a[12:15], v[40:43], v[128:143]
    v_mfma_f32_32x32x16_bf16 v[144:159], a[12:15], v[44:47], v[144:159]
    ds_read_b128 v[40:43], v243 offset:11264
    ds_read_b128 v[44:47], v243 offset:35840
    s_waitcnt vmcnt(19) lgkmcnt(6)
    v_mfma_f32_32x32x16_bf16 v[128:143], a[16:19], v[16:19], v[128:143]
    v_mfma_f32_32x32x16_bf16 v[144:159], a[16:19], v[20:23], v[144:159]
    ds_read_b128 v[16:19], v240 offset:12288
    ds_read_b128 v[20:23], v240 offset:36864
    s_waitcnt vmcnt(18) lgkmcnt(6)
    v_mfma_f32_32x32x16_bf16 v[128:143], a[20:23], v[24:27], v[128:143]
    v_mfma_f32_32x32x16_bf16 v[144:159], a[20:23], v[28:31], v[144:159]
    ds_read_b128 v[24:27], v241 offset:13312
    ds_read_b128 v[28:31], v241 offset:37888
    s_waitcnt vmcnt(17) lgkmcnt(6)
    v_mfma_f32_32x32x16_bf16 v[128:143], a[24:27], v[32:35], v[128:143]
    v_mfma_f32_32x32x16_bf16 v[144:159], a[24:27], v[36:39], v[144:159]
    ds_read_b128 v[32:35], v242 offset:14336
    ds_read_b128 v[36:39], v242 offset:38912
    s_waitcnt vmcnt(16) lgkmcnt(6)
    v_mfma_f32_32x32x16_bf16 v[128:143], a[28:31], v[40:43], v[128:143]
    v_mfma_f32_32x32x16_bf16 v[144:159], a[28:31], v[44:47], v[144:159]
    ds_read_b128 v[40:43], v243 offset:15360
    ds_read_b128 v[44:47], v243 offset:39936
    s_waitcnt vmcnt(15) lgkmcnt(6)
    v_mfma_f32_32x32x16_bf16 v[128:143], a[32:35], v[16:19], v[128:143]
    v_mfma_f32_32x32x16_bf16 v[144:159], a[32:35], v[20:23], v[144:159]
    ds_read_b128 v[16:19], v240 offset:16384
    ds_read_b128 v[20:23], v240 offset:40960
    s_waitcnt vmcnt(14) lgkmcnt(6)
    v_mfma_f32_32x32x16_bf16 v[128:143], a[36:39], v[24:27], v[128:143]
    v_mfma_f32_32x32x16_bf16 v[144:159], a[36:39], v[28:31], v[144:159]
    ds_read_b128 v[24:27], v241 offset:17408
    ds_read_b128 v[28:31], v241 offset:41984
    s_waitcnt vmcnt(13) lgkmcnt(6)
    v_mfma_f32_32x32x16_bf16 v[128:143], a[40:43], v[32:35], v[128:143]
    v_mfma_f32_32x32x16_bf16 v[144:159], a[40:43], v[36:39], v[144:159]
    ds_read_b128 v[32:35], v242 offset:18432
    ds_read_b128 v[36:39], v242 offset:43008
    s_waitcnt vmcnt(12) lgkmcnt(6)
    v_mfma_f32_32x32x16_bf16 v[128:143], a[44:47], v[40:43], v[128:143]
    v_mfma_f32_32x32x16_bf16 v[144:159], a[44:47], v[44:47], v[144:159]
    ds_read_b128 v[40:43], v243 offset:19456
    ds_read_b128 v[44:47], v243 offset:44032
    s_waitcnt vmcnt(11) lgkmcnt(6)
    v_mfma_f32_32x32x16_bf16 v[128:143], a[48:51], v[16:19], v[128:143]
    v_mfma_f32_32x32x16_bf16 v[144:159], a[48:51], v[20:23], v[144:159]
    ds_read_b128 v[16:19], v240 offset:20480
    ds_read_b128 v[20:23], v240 offset:45056
    s_waitcnt vmcnt(10) lgkmcnt(6)
    v_mfma_f32_32x32x16_bf16 v[128:143], a[52:55], v[24:27], v[128:143]
    v_mfma_f32_32x32x16_bf16 v[144:159], a[52:55], v[28:31], v[144:159]
    ds_read_b128 v[24:27], v241 offset:21504
    ds_read_b128 v[28:31], v241 offset:46080
    s_waitcnt vmcnt(9) lgkmcnt(6)
    v_mfma_f32_32x32x16_bf16 v[128:143], a[56:59], v[32:35], v[128:143]
    v_mfma_f32_32x32x16_bf16 v[144:159], a[56:59], v[36:39], v[144:159]
    ds_read_b128 v[32:35], v242 offset:22528
    ds_read_b128 v[36:39], v242 offset:47104
    s_waitcnt vmcnt(8) lgkmcnt(6)
    v_mfma_f32_32x32x16_bf16 v[128:143], a[60:63], v[40:43], v[128:143]
    v_mfma_f32_32x32x16_bf16 v[144:159], a[60:63], v[44:47], v[144:159]
    ds_read_b128 v[40:43], v243 offset:23552
    ds_read_b128 v[44:47], v243 offset:48128
    s_waitcnt vmcnt(7) lgkmcnt(6)
    v_mfma_f32_32x32x16_bf16 v[128:143], a[64:67], v[16:19], v[128:143]
    v_mfma_f32_32x32x16_bf16 v[144:159], a[64:67], v[20:23], v[144:159]
    ds_read_b128 v[16:19], v240 offset:24576
    ds_read_b128 v[20:23], v240 offset:49152
    s_waitcnt vmcnt(6) lgkmcnt(6)
    v_mfma_f32_32x32x16_bf16 v[128:143], a[68:71], v[24:27], v[128:143]
    v_mfma_f32_32x32x16_bf16 v[144:159], a[68:71], v[28:31], v[144:159]
    ds_read_b128 v[24:27], v241 offset:25600
    ds_read_b128 v[28:31], v241 offset:50176
    s_waitcnt vmcnt(5) lgkmcnt(6)
    v_mfma_f32_32x32x16_bf16 v[128:143], a[72:75], v[32:35], v[128:143]
    v_mfma_f32_32x32x16_bf16 v[144:159], a[72:75], v[36:39], v[144:159]
    ds_read_b128 v[32:35], v242 offset:26624
    ds_read_b128 v[36:39], v242 offset:51200
    s_waitcnt vmcnt(4) lgkmcnt(6)
    v_mfma_f32_32x32x16_bf16 v[128:143], a[76:79], v[40:43], v[128:143]
    v_mfma_f32_32x32x16_bf16 v[144:159], a[76:79], v[44:47], v[144:159]
    ds_read_b128 v[40:43], v243 offset:27648
    ds_read_b128 v[44:47], v243 offset:52224
    s_waitcnt vmcnt(3) lgkmcnt(6)
    v_mfma_f32_32x32x16_bf16 v[128:143], a[80:83], v[16:19], v[128:143]
    v_mfma_f32_32x32x16_bf16 v[144:159], a[80:83], v[20:23], v[144:159]
    s_lshl_b32 s12, s10, 7
    v_lshlrev_b32 v7, 4, v4
    v_add_u32 v7, s12, v7
    ds_read_b128 v[96:99], v7 offset:1536
    ds_read_b128 v[100:103], v7 offset:1568
    ds_read_b128 v[104:107], v7 offset:1600
    ds_read_b128 v[108:111], v7 offset:1632
    s_waitcnt vmcnt(2) lgkmcnt(8)
    v_mfma_f32_32x32x16_bf16 v[128:143], a[84:87], v[24:27], v[128:143]
    v_mfma_f32_32x32x16_bf16 v[144:159], a[84:87], v[28:31], v[144:159]
    s_waitcnt vmcnt(1) lgkmcnt(6)
    v_mfma_f32_32x32x16_bf16 v[128:143], a[88:91], v[32:35], v[128:143]
    v_mfma_f32_32x32x16_bf16 v[144:159], a[88:91], v[36:39], v[144:159]
    s_waitcnt vmcnt(0) lgkmcnt(4)
    v_mfma_f32_32x32x16_bf16 v[128:143], a[92:95], v[40:43], v[128:143]
    v_mfma_f32_32x32x16_bf16 v[144:159], a[92:95], v[44:47], v[144:159]
    s_mul_i32 s12, s4, 49152
    s_lshl_b32 s13, s10, 11
    s_add_u32 s12, s12, s13
    s_add_u32 s12, s12, 2621440
    s_add_u32 s13, s12, 24576
    s_nop 6
    s_waitcnt lgkmcnt(0)
    v_pk_mul_f32 v[128:129], v[128:129], v[96:97]
    v_pk_mul_f32 v[130:131], v[130:131], v[98:99]
    v_pk_mul_f32 v[132:133], v[132:133], v[100:101]
    v_pk_mul_f32 v[134:135], v[134:135], v[102:103]
    v_pk_mul_f32 v[136:137], v[136:137], v[104:105]
    v_pk_mul_f32 v[138:139], v[138:139], v[106:107]
    v_pk_mul_f32 v[140:141], v[140:141], v[108:109]
    v_pk_mul_f32 v[142:143], v[142:143], v[110:111]
    v_cvt_pk_bf16_f32 v16, v128, v129
    v_cvt_pk_bf16_f32 v17, v130, v131
    v_cvt_pk_bf16_f32 v18, v132, v133
    v_cvt_pk_bf16_f32 v19, v134, v135
    v_cvt_pk_bf16_f32 v20, v136, v137
    v_cvt_pk_bf16_f32 v21, v138, v139
    v_cvt_pk_bf16_f32 v22, v140, v141
    v_cvt_pk_bf16_f32 v23, v142, v143
    s_nop 1
    v_permlane32_swap_b32 v16, v18
    v_permlane32_swap_b32 v17, v19
    v_permlane32_swap_b32 v20, v22
    v_permlane32_swap_b32 v21, v23
    buffer_store_dwordx4 v[16:19], v5, s[40:43], s12 offen offset:0 sc1
    buffer_store_dwordx4 v[20:23], v5, s[40:43], s12 offen offset:1024 sc1
    v_pk_mul_f32 v[144:145], v[144:145], v[96:97]
    v_pk_mul_f32 v[146:147], v[146:147], v[98:99]
    v_pk_mul_f32 v[148:149], v[148:149], v[100:101]
    v_pk_mul_f32 v[150:151], v[150:151], v[102:103]
    v_pk_mul_f32 v[152:153], v[152:153], v[104:105]
    v_pk_mul_f32 v[154:155], v[154:155], v[106:107]
    v_pk_mul_f32 v[156:157], v[156:157], v[108:109]
    v_pk_mul_f32 v[158:159], v[158:159], v[110:111]
    v_cvt_pk_bf16_f32 v24, v144, v145
    v_cvt_pk_bf16_f32 v25, v146, v147
    v_cvt_pk_bf16_f32 v26, v148, v149
    v_cvt_pk_bf16_f32 v27, v150, v151
    v_cvt_pk_bf16_f32 v28, v152, v153
    v_cvt_pk_bf16_f32 v29, v154, v155
    v_cvt_pk_bf16_f32 v30, v156, v157
    v_cvt_pk_bf16_f32 v31, v158, v159
    s_nop 1
    v_permlane32_swap_b32 v24, v26
    v_permlane32_swap_b32 v25, v27
    v_permlane32_swap_b32 v28, v30
    v_permlane32_swap_b32 v29, v31
    buffer_store_dwordx4 v[24:27], v5, s[40:43], s13 offen offset:0 sc1
    buffer_store_dwordx4 v[28:31], v5, s[40:43], s13 offen offset:1024 sc1
    s_branch F2_FIN
F2_V:
    ds_read_b128 v[16:19], v240 offset:4096
    ds_read_b128 v[20:23], v240 offset:28672
    ds_read_b128 v[24:27], v241 offset:5120
    ds_read_b128 v[28:31], v241 offset:29696
    ds_read_b128 v[32:35], v242 offset:6144
    ds_read_b128 v[36:39], v242 offset:30720
    ds_read_b128 v[40:43], v243 offset:7168
    ds_read_b128 v[44:47], v243 offset:31744
    s_waitcnt vmcnt(23) lgkmcnt(6)
    v_mfma_f32_32x32x16_bf16 v[128:143], v[16:19], a[0:3], 0
    v_mfma_f32_32x32x16_bf16 v[144:159], v[20:23], a[0:3], 0
    ds_read_b128 v[16:19], v240 offset:8192
    ds_read_b128 v[20:23], v240 offset:32768
    s_waitcnt vmcnt(22) lgkmcnt(6)
    v_mfma_f32_32x32x16_bf16 v[128:143], v[24:27], a[4:7], v[128:143]
    v_mfma_f32_32x32x16_bf16 v[144:159], v[28:31], a[4:7], v[144:159]
    ds_read_b128 v[24:27], v241 offset:9216
    ds_read_b128 v[28:31], v241 offset:33792
    s_waitcnt vmcnt(21) lgkmcnt(6)
    v_mfma_f32_32x32x16_bf16 v[128:143], v[32:35], a[8:11], v[128:143]
    v_mfma_f32_32x32x16_bf16 v[144:159], v[36:39], a[8:11], v[144:159]
    ds_read_b128 v[32:35], v242 offset:10240
    ds_read_b128 v[36:39], v242 offset:34816
    s_waitcnt vmcnt(20) lgkmcnt(6)
    v_mfma_f32_32x32x16_bf16 v[128:143], v[40:43], a[12:15], v[128:143]
    v_mfma_f32_32x32x16_bf16 v[144:159], v[44:47], a[12:15], v[144:159]
    ds_read_b128 v[40:43], v243 offset:11264
    ds_read_b128 v[44:47], v243 offset:35840
    s_waitcnt vmcnt(19) lgkmcnt(6)
    v_mfma_f32_32x32x16_bf16 v[128:143], v[16:19], a[16:19], v[128:143]
    v_mfma_f32_32x32x16_bf16 v[144:159], v[20:23], a[16:19], v[144:159]
    ds_read_b128 v[16:19], v240 offset:12288
    ds_read_b128 v[20:23], v240 offset:36864
    s_waitcnt vmcnt(18) lgkmcnt(6)
    v_mfma_f32_32x32x16_bf16 v[128:143], v[24:27], a[20:23], v[128:143]
    v_mfma_f32_32x32x16_bf16 v[144:159], v[28:31], a[20:23], v[144:159]
    ds_read_b128 v[24:27], v241 offset:13312
    ds_read_b128 v[28:31], v241 offset:37888
    s_waitcnt vmcnt(17) lgkmcnt(6)
    v_mfma_f32_32x32x16_bf16 v[128:143], v[32:35], a[24:27], v[128:143]
    v_mfma_f32_32x32x16_bf16 v[144:159], v[36:39], a[24:27], v[144:159]
    ds_read_b128 v[32:35], v242 offset:14336
    ds_read_b128 v[36:39], v242 offset:38912
    s_waitcnt vmcnt(16) lgkmcnt(6)
    v_mfma_f32_32x32x16_bf16 v[128:143], v[40:43], a[28:31], v[128:143]
    v_mfma_f32_32x32x16_bf16 v[144:159], v[44:47], a[28:31], v[144:159]
    ds_read_b128 v[40:43], v243 offset:15360
    ds_read_b128 v[44:47], v243 offset:39936
    s_waitcnt vmcnt(15) lgkmcnt(6)
    v_mfma_f32_32x32x16_bf16 v[128:143], v[16:19], a[32:35], v[128:143]
    v_mfma_f32_32x32x16_bf16 v[144:159], v[20:23], a[32:35], v[144:159]
    ds_read_b128 v[16:19], v240 offset:16384
    ds_read_b128 v[20:23], v240 offset:40960
    s_waitcnt vmcnt(14) lgkmcnt(6)
    v_mfma_f32_32x32x16_bf16 v[128:143], v[24:27], a[36:39], v[128:143]
    v_mfma_f32_32x32x16_bf16 v[144:159], v[28:31], a[36:39], v[144:159]
    ds_read_b128 v[24:27], v241 offset:17408
    ds_read_b128 v[28:31], v241 offset:41984
    s_waitcnt vmcnt(13) lgkmcnt(6)
    v_mfma_f32_32x32x16_bf16 v[128:143], v[32:35], a[40:43], v[128:143]
    v_mfma_f32_32x32x16_bf16 v[144:159], v[36:39], a[40:43], v[144:159]
    ds_read_b128 v[32:35], v242 offset:18432
    ds_read_b128 v[36:39], v242 offset:43008
    s_waitcnt vmcnt(12) lgkmcnt(6)
    v_mfma_f32_32x32x16_bf16 v[128:143], v[40:43], a[44:47], v[128:143]
    v_mfma_f32_32x32x16_bf16 v[144:159], v[44:47], a[44:47], v[144:159]
    ds_read_b128 v[40:43], v243 offset:19456
    ds_read_b128 v[44:47], v243 offset:44032
    s_waitcnt vmcnt(11) lgkmcnt(6)
    v_mfma_f32_32x32x16_bf16 v[128:143], v[16:19], a[48:51], v[128:143]
    v_mfma_f32_32x32x16_bf16 v[144:159], v[20:23], a[48:51], v[144:159]
    ds_read_b128 v[16:19], v240 offset:20480
    ds_read_b128 v[20:23], v240 offset:45056
    s_waitcnt vmcnt(10) lgkmcnt(6)
    v_mfma_f32_32x32x16_bf16 v[128:143], v[24:27], a[52:55], v[128:143]
    v_mfma_f32_32x32x16_bf16 v[144:159], v[28:31], a[52:55], v[144:159]
    ds_read_b128 v[24:27], v241 offset:21504
    ds_read_b128 v[28:31], v241 offset:46080
    s_waitcnt vmcnt(9) lgkmcnt(6)
    v_mfma_f32_32x32x16_bf16 v[128:143], v[32:35], a[56:59], v[128:143]
    v_mfma_f32_32x32x16_bf16 v[144:159], v[36:39], a[56:59], v[144:159]
    ds_read_b128 v[32:35], v242 offset:22528
    ds_read_b128 v[36:39], v242 offset:47104
    s_waitcnt vmcnt(8) lgkmcnt(6)
    v_mfma_f32_32x32x16_bf16 v[128:143], v[40:43], a[60:63], v[128:143]
    v_mfma_f32_32x32x16_bf16 v[144:159], v[44:47], a[60:63], v[144:159]
    ds_read_b128 v[40:43], v243 offset:23552
    ds_read_b128 v[44:47], v243 offset:48128
    s_waitcnt vmcnt(7) lgkmcnt(6)
    v_mfma_f32_32x32x16_bf16 v[128:143], v[16:19], a[64:67], v[128:143]
    v_mfma_f32_32x32x16_bf16 v[144:159], v[20:23], a[64:67], v[144:159]
    ds_read_b128 v[16:19], v240 offset:24576
    ds_read_b128 v[20:23], v240 offset:49152
    s_waitcnt vmcnt(6) lgkmcnt(6)
    v_mfma_f32_32x32x16_bf16 v[128:143], v[24:27], a[68:71], v[128:143]
    v_mfma_f32_32x32x16_bf16 v[144:159], v[28:31], a[68:71], v[144:159]
    ds_read_b128 v[24:27], v241 offset:25600
    ds_read_b128 v[28:31], v241 offset:50176
    s_waitcnt vmcnt(5) lgkmcnt(6)
    v_mfma_f32_32x32x16_bf16 v[128:143], v[32:35], a[72:75], v[128:143]
    v_mfma_f32_32x32x16_bf16 v[144:159], v[36:39], a[72:75], v[144:159]
    ds_read_b128 v[32:35], v242 offset:26624
    ds_read_b128 v[36:39], v242 offset:51200
    s_waitcnt vmcnt(4) lgkmcnt(6)
    v_mfma_f32_32x32x16_bf16 v[128:143], v[40:43], a[76:79], v[128:143]
    v_mfma_f32_32x32x16_bf16 v[144:159], v[44:47], a[76:79], v[144:159]
    ds_read_b128 v[40:43], v243 offset:27648
    ds_read_b128 v[44:47], v243 offset:52224
    s_waitcnt vmcnt(3) lgkmcnt(6)
    v_mfma_f32_32x32x16_bf16 v[128:143], v[16:19], a[80:83], v[128:143]
    v_mfma_f32_32x32x16_bf16 v[144:159], v[20:23], a[80:83], v[144:159]
    s_waitcnt vmcnt(2) lgkmcnt(4)
    v_mfma_f32_32x32x16_bf16 v[128:143], v[24:27], a[84:87], v[128:143]
    v_mfma_f32_32x32x16_bf16 v[144:159], v[28:31], a[84:87], v[144:159]
    s_waitcnt vmcnt(1) lgkmcnt(2)
    v_mfma_f32_32x32x16_bf16 v[128:143], v[32:35], a[88:91], v[128:143]
    v_mfma_f32_32x32x16_bf16 v[144:159], v[36:39], a[88:91], v[144:159]
    s_waitcnt vmcnt(0) lgkmcnt(0)
    v_mfma_f32_32x32x16_bf16 v[128:143], v[40:43], a[92:95], v[128:143]
    v_mfma_f32_32x32x16_bf16 v[144:159], v[44:47], a[92:95], v[144:159]
    s_mul_i32 s12, s6, 786432
    s_sub_u32 s13, s10, 12
    s_lshl_b32 s13, s13, 16
    s_add_u32 s12, s12, s13
    s_and_b32 s13, s4, 15
    s_lshl_b32 s13, s13, 12
    s_add_u32 s12, s12, s13
    s_add_u32 s12, s12, 4194304
    s_nop 3
    v_cvt_pk_bf16_f32 v16, v128, v129
    v_cvt_pk_bf16_f32 v17, v130, v131
    v_cvt_pk_bf16_f32 v18, v132, v133
    v_cvt_pk_bf16_f32 v19, v134, v135
    v_cvt_pk_bf16_f32 v20, v136, v137
    v_cvt_pk_bf16_f32 v21, v138, v139
    v_cvt_pk_bf16_f32 v22, v140, v141
    v_cvt_pk_bf16_f32 v23, v142, v143
    buffer_store_dwordx4 v[16:19], v5, s[40:43], s12 offen offset:0 sc1
    buffer_store_dwordx4 v[20:23], v5, s[40:43], s12 offen offset:1024 sc1
    v_cvt_pk_bf16_f32 v24, v144, v145
    v_cvt_pk_bf16_f32 v25, v146, v147
    v_cvt_pk_bf16_f32 v26, v148, v149
    v_cvt_pk_bf16_f32 v27, v150, v151
    v_cvt_pk_bf16_f32 v28, v152, v153
    v_cvt_pk_bf16_f32 v29, v154, v155
    v_cvt_pk_bf16_f32 v30, v156, v157
    v_cvt_pk_bf16_f32 v31, v158, v159
    buffer_store_dwordx4 v[24:27], v5, s[40:43], s12 offen offset:2048 sc1
    buffer_store_dwordx4 v[28:31], v5, s[40:43], s12 offen offset:3072 sc1
F2_FIN:
    s_lshl_b32 s12, s4, 2
    s_add_u32 s12, s12, s5
    s_add_u32 s12, s12, 226
    s_lshl_b32 s13, s6, 2
    s_add_u32 s13, s13, s5
    s_lshl_b32 s13, s13, 4
    s_and_b32 s14, s4, 15
    s_add_u32 s13, s13, s14
    s_add_u32 s13, s13, 290
    s_cmp_lt_u32 s5, 4
    s_cselect_b32 s12, s12, s13
    s_lshl_b32 s12, s12, 6
    s_add_u32 s12, s12, 10485760
    s_lshl_b32 s13, s62, 8
    s_add_u32 s13, s13, 10500224
    s_lshl_b32 s14, s6, 2
    s_add_u32 s14, s14, s65
    s_lshl_b32 s14, s14, 10
    s_add_u32 s14, s14, 10508160
    v_lshlrev_b32 v9, 6, v1
    v_add_u32 v10, s14, v9
    v_add_u32 v9, s13, v9
    v_cmp_gt_u32 vcc, 4, v1
    v_mov_b32 v11, s13
    s_nop 0
    v_cndmask_b32 v10, v10, v9, vcc
    v_cmp_gt_u32 vcc, 20, v1
    s_nop 1
    v_cndmask_b32 v10, v11, v10, vcc
    s_waitcnt vmcnt(0)
    s_barrier
    s_cmp_lg_u32 s3, 0
    s_cbranch_scc1 F2_NOFLAG
    v_mov_b32 v12, s68
    v_mov_b32 v13, s69
    v_mov_b32 v14, 0
    s_mov_b64 exec, 1
    buffer_store_dwordx2 v[12:13], v14, s[40:43], s12 offen sc0 sc1
    s_mov_b64 exec, -1
F2_NOFLAG:
    buffer_load_dwordx4 a[96:99], v5, s[40:43], s67 offen offset:0 sc1
    buffer_load_dwordx4 a[100:103], v5, s[40:43], s67 offen offset:1024 sc1
    buffer_load_dwordx4 a[104:107], v5, s[40:43], s67 offen offset:2048 sc1
    buffer_load_dwordx4 a[108:111], v5, s[40:43], s67 offen offset:3072 sc1
    s_add_u32 s67, s67, 4096
    buffer_load_dwordx4 a[112:115], v5, s[40:43], s67 offen offset:0 sc1
    buffer_load_dwordx4 a[116:119], v5, s[40:43], s67 offen offset:1024 sc1
    buffer_load_dwordx4 a[120:123], v5, s[40:43], s67 offen offset:2048 sc1
    buffer_load_dwordx4 a[124:127], v5, s[40:43], s67 offen offset:3072 sc1
    s_add_u32 s67, s67, 4096
    buffer_load_dwordx4 a[128:131], v5, s[40:43], s67 offen offset:0 sc1
    buffer_load_dwordx4 a[132:135], v5, s[40:43], s67 offen offset:1024 sc1
    buffer_load_dwordx4 a[136:139], v5, s[40:43], s67 offen offset:2048 sc1
    buffer_load_dwordx4 a[140:143], v5, s[40:43], s67 offen offset:3072 sc1
    s_add_u32 s67, s67, 4096
    buffer_load_dwordx4 a[144:147], v5, s[40:43], s67 offen offset:0 sc1
    buffer_load_dwordx4 a[148:151], v5, s[40:43], s67 offen offset:1024 sc1
    buffer_load_dwordx4 a[152:155], v5, s[40:43], s67 offen offset:2048 sc1
    buffer_load_dwordx4 a[156:159], v5, s[40:43], s67 offen offset:3072 sc1
    s_add_u32 s67, s67, 4096
    buffer_load_dwordx4 a[160:163], v5, s[40:43], s67 offen offset:0 sc1
    buffer_load_dwordx4 a[164:167], v5, s[40:43], s67 offen offset:1024 sc1
    buffer_load_dwordx4 a[168:171], v5, s[40:43], s67 offen offset:2048 sc1
    buffer_load_dwordx4 a[172:175], v5, s[40:43], s67 offen offset:3072 sc1
    s_add_u32 s67, s67, 4096
    buffer_load_dwordx4 a[176:179], v5, s[40:43], s67 offen offset:0 sc1
    buffer_load_dwordx4 a[180:183], v5, s[40:43], s67 offen offset:1024 sc1
    buffer_load_dwordx4 a[184:187], v5, s[40:43], s67 offen offset:2048 sc1
    buffer_load_dwordx4 a[188:191], v5, s[40:43], s67 offen offset:3072 sc1
    s_mul_i32 s11, s3, 3072
    s_mul_i32 s10, s62, 49152
    s_add_u32 s10, s10, s11
    s_add_u32 s10, s10, 2621440
    v_lshlrev_b32 v6, 3, v1
    s_lshl_b32 s14, s62, 17
    s_lshl_b32 s15, s66, 11
    s_add_u32 s14, s14, s15
    s_add_u32 s14, s14, 6291456
    s_add_u32 s15, s14, 65536
    s_lshl_b32 s8, s62, 14
    s_lshl_b32 s9, s66, 9
    s_add_u32 s8, s8, s9
    s_add_u32 s8, s8, 5767168
    s_mul_i32 s12, s6, 786432
    s_mul_i32 s13, s65, 196608
    s_add_u32 s12, s12, s13
    s_lshl_b32 s13, s3, 14
    s_add_u32 s12, s12, s13
    s_add_u32 s52, s12, 4194304
    s_add_u32 s53, s52, 65536
    s_add_u32 s54, s52, 131072
    s_lshl_b32 s13, s3, 3
    v_add_u32 v7, s13, v1
    v_and_b32 v7, 31, v7
    v_lshlrev_b32 v7, 4, v7
    v_lshl_add_u32 v248, v4, 9, v7
    v_add_u32 v249, 4096, v248
    v_add_u32 v250, 8192, v248
    v_add_u32 v251, 12288, v248
    v_add_u32 v252, 4096, v5
    v_add_u32 v253, 8192, v5
    v_add_u32 v254, 12288, v5
    v_and_b32 v247, 31, v1
    v_lshlrev_b32 v247, 4, v247
    s_lshl_b32 s13, s3, 2
    v_add_u32 v255, s13, v247
    s_cmp_lg_u32 s3, 0
    s_cbranch_scc1 H2_SKIP
    s_mov_b32 s58, 0
H2_POLL:
    buffer_load_dwordx2 v[12:13], v10, s[40:43], 0 offen sc1
    s_add_u32 s58, s58, 1
    s_waitcnt vmcnt(0)
    v_cmp_ne_u32 vcc, s68, v12
    v_cmp_ne_u32 s[56:57], s69, v13
    s_cmp_gt_u32 s58, 100000
    s_cbranch_scc1 H2_DONE
    s_or_b64 vcc, vcc, s[56:57]
    s_cbranch_vccz H2_DONE
    s_sleep 1
    s_branch H2_POLL
H2_DONE:
H2_SKIP:
    s_barrier
    s_add_u32 m0, s11, 0
    s_nop 0
    buffer_load_dwordx4 v5, s[40:43], s10 offen offset:0 sc1 lds
    buffer_load_dwordx4 v5, s[40:43], s10 offen offset:1024 sc1 lds
    buffer_load_dwordx4 v5, s[40:43], s10 offen offset:2048 sc1 lds
    s_add_u32 s10, s10, 12288
    s_add_u32 m0, s11, 12288
    s_nop 0
    buffer_load_dwordx4 v5, s[40:43], s10 offen offset:0 sc1 lds
    buffer_load_dwordx4 v5, s[40:43], s10 offen offset:1024 sc1 lds
    buffer_load_dwordx4 v5, s[40:43], s10 offen offset:2048 sc1 lds
    s_add_u32 s10, s10, 12288
    s_add_u32 m0, s11, 24576
    s_nop 0
    buffer_load_dwordx4 v5, s[40:43], s10 offen offset:0 sc1 lds
    buffer_load_dwordx4 v5, s[40:43], s10 offen offset:1024 sc1 lds
    buffer_load_dwordx4 v5, s[40:43], s10 offen offset:2048 sc1 lds
    s_add_u32 s10, s10, 12288
    s_add_u32 m0, s11, 36864
    s_nop 0
    buffer_load_dwordx4 v5, s[40:43], s10 offen offset:0 sc1 lds
    buffer_load_dwordx4 v5, s[40:43], s10 offen offset:1024 sc1 lds
    buffer_load_dwordx4 v5, s[40:43], s10 offen offset:2048 sc1 lds
    s_waitcnt vmcnt(9)
    s_barrier
    ds_read_b128 v[16:19], v5 offset:0
    ds_read_b128 v[20:23], v5 offset:1024
    ds_read_b128 v[24:27], v5 offset:2048
    ds_read_b128 v[28:31], v5 offset:3072
    ds_read_b128 v[32:35], v5 offset:4096
    ds_read_b128 v[36:39], v5 offset:5120
    s_waitcnt lgkmcnt(5)
    v_mfma_f32_32x32x16_bf16 v[64:79], a[96:99], v[16:19], 0
    buffer_load_dwordx4 a[0:3], v248, s[40:43], s52 offen offset:0 sc1
    ds_read_b128 v[16:19], v5 offset:6144
    s_waitcnt lgkmcnt(5)
    v_mfma_f32_32x32x16_bf16 v[64:79], a[100:103], v[20:23], v[64:79]
    ds_read_b128 v[20:23], v5 offset:7168
    s_waitcnt lgkmcnt(5)
    v_mfma_f32_32x32x16_bf16 v[64:79], a[104:107], v[24:27], v[64:79]
    buffer_load_dwordx4 a[4:7], v248, s[40:43], s53 offen offset:0 sc1
    ds_read_b128 v[24:27], v5 offset:8192
    s_waitcnt lgkmcnt(5)
    v_mfma_f32_32x32x16_bf16 v[64:79], a[108:111], v[28:31], v[64:79]
    ds_read_b128 v[28:31], v5 offset:9216
    s_waitcnt lgkmcnt(5)
    v_mfma_f32_32x32x16_bf16 v[64:79], a[112:115], v[32:35], v[64:79]
    buffer_load_dwordx4 a[8:11], v248, s[40:43], s54 offen offset:0 sc1
    ds_read_b128 v[32:35], v5 offset:10240
    s_waitcnt lgkmcnt(5)
    v_mfma_f32_32x32x16_bf16 v[64:79], a[116:119], v[36:39], v[64:79]
    ds_read_b128 v[36:39], v5 offset:11264
    s_waitcnt lgkmcnt(5)
    v_mfma_f32_32x32x16_bf16 v[64:79], a[120:123], v[16:19], v[64:79]
    buffer_load_dwordx4 a[12:15], v248, s[40:43], s52 offen offset:1024 sc1
    s_waitcnt vmcnt(10)
    s_barrier
    ds_read_b128 v[16:19], v5 offset:12288
    s_waitcnt lgkmcnt(5)
    v_mfma_f32_32x32x16_bf16 v[64:79], a[124:127], v[20:23], v[64:79]
    ds_read_b128 v[20:23], v5 offset:13312
    s_waitcnt lgkmcnt(5)
    v_mfma_f32_32x32x16_bf16 v[64:79], a[128:131], v[24:27], v[64:79]
    buffer_load_dwordx4 a[16:19], v248, s[40:43], s53 offen offset:1024 sc1
    ds_read_b128 v[24:27], v5 offset:14336
    s_waitcnt lgkmcnt(5)
    v_mfma_f32_32x32x16_bf16 v[64:79], a[132:135], v[28:31], v[64:79]
    ds_read_b128 v[28:31], v5 offset:15360
    s_waitcnt lgkmcnt(5)
    v_mfma_f32_32x32x16_bf16 v[64:79], a[136:139], v[32:35], v[64:79]
    buffer_load_dwordx4 a[20:23], v248, s[40:43], s54 offen offset:1024 sc1
    ds_read_b128 v[32:35], v5 offset:16384
    s_waitcnt lgkmcnt(5)
    v_mfma_f32_32x32x16_bf16 v[64:79], a[140:143], v[36:39], v[64:79]
    ds_read_b128 v[36:39], v5 offset:17408
    s_waitcnt lgkmcnt(5)
    v_mfma_f32_32x32x16_bf16 v[64:79], a[144:147], v[16:19], v[64:79]
    buffer_load_dwordx4 a[24:27], v248, s[40:43], s52 offen offset:2048 sc1
    ds_read_b128 v[16:19], v5 offset:18432
    s_waitcnt lgkmcnt(5)
    v_mfma_f32_32x32x16_bf16 v[64:79], a[148:151], v[20:23], v[64:79]
    ds_read_b128 v[20:23], v5 offset:19456
    s_waitcnt lgkmcnt(5)
    v_mfma_f32_32x32x16_bf16 v[64:79], a[152:155], v[24:27], v[64:79]
    buffer_load_dwordx4 a[28:31], v248, s[40:43], s53 offen offset:2048 sc1
    ds_read_b128 v[24:27], v5 offset:20480
    s_waitcnt lgkmcnt(5)
    v_mfma_f32_32x32x16_bf16 v[64:79], a[156:159], v[28:31], v[64:79]
    ds_read_b128 v[28:31], v5 offset:21504
    s_waitcnt lgkmcnt(5)
    v_mfma_f32_32x32x16_bf16 v[64:79], a[160:163], v[32:35], v[64:79]
    buffer_load_dwordx4 a[32:35], v248, s[40:43], s54 offen offset:2048 sc1
    ds_read_b128 v[32:35], v5 offset:22528
    s_waitcnt lgkmcnt(5)
    v_mfma_f32_32x32x16_bf16 v[64:79], a[164:167], v[36:39], v[64:79]
    ds_read_b128 v[36:39], v5 offset:23552
    s_waitcnt lgkmcnt(5)
    v_mfma_f32_32x32x16_bf16 v[64:79], a[168:171], v[16:19], v[64:79]
    buffer_load_dwordx4 a[36:39], v248, s[40:43], s52 offen offset:3072 sc1
    s_waitcnt vmcnt(13)
    s_barrier
    ds_read_b128 v[16:19], v5 offset:24576
    s_waitcnt lgkmcnt(5)
    v_mfma_f32_32x32x16_bf16 v[64:79], a[172:175], v[20:23], v[64:79]
    ds_read_b128 v[20:23], v5 offset:25600
    s_waitcnt lgkmcnt(5)
    v_mfma_f32_32x32x16_bf16 v[64:79], a[176:179], v[24:27], v[64:79]
    buffer_load_dwordx4 a[40:43], v248, s[40:43], s53 offen offset:3072 sc1
    ds_read_b128 v[24:27], v5 offset:26624
    s_waitcnt lgkmcnt(5)
    v_mfma_f32_32x32x16_bf16 v[64:79], a[180:183], v[28:31], v[64:79]
    ds_read_b128 v[28:31], v5 offset:27648
    s_waitcnt lgkmcnt(5)
    v_mfma_f32_32x32x16_bf16 v[64:79], a[184:187], v[32:35], v[64:79]
    buffer_load_dwordx4 a[44:47], v248, s[40:43], s54 offen offset:3072 sc1
    ds_read_b128 v[32:35], v5 offset:28672
    s_waitcnt lgkmcnt(5)
    v_mfma_f32_32x32x16_bf16 v[64:79], a[188:191], v[36:39], v[64:79]
    ds_read_b128 v[36:39], v5 offset:29696
    s_waitcnt lgkmcnt(5)
    v_mfma_f32_32x32x16_bf16 v[80:95], a[96:99], v[16:19], 0
    buffer_load_dwordx4 a[48:51], v249, s[40:43], s52 offen offset:0 sc1
    ds_read_b128 v[16:19], v5 offset:30720
    s_waitcnt lgkmcnt(5)
    v_mfma_f32_32x32x16_bf16 v[80:95], a[100:103], v[20:23], v[80:95]
    ds_read_b128 v[20:23], v5 offset:31744
    s_waitcnt lgkmcnt(5)
    v_mfma_f32_32x32x16_bf16 v[80:95], a[104:107], v[24:27], v[80:95]
    buffer_load_dwordx4 a[52:55], v249, s[40:43], s53 offen offset:0 sc1
    ds_read_b128 v[24:27], v5 offset:32768
    s_waitcnt lgkmcnt(5)
    v_mfma_f32_32x32x16_bf16 v[80:95], a[108:111], v[28:31], v[80:95]
    ds_read_b128 v[28:31], v5 offset:33792
    s_waitcnt lgkmcnt(5)
    v_mfma_f32_32x32x16_bf16 v[80:95], a[112:115], v[32:35], v[80:95]
    buffer_load_dwordx4 a[56:59], v249, s[40:43], s54 offen offset:0 sc1
    ds_read_b128 v[32:35], v5 offset:34816
    s_waitcnt lgkmcnt(5)
    v_mfma_f32_32x32x16_bf16 v[80:95], a[116:119], v[36:39], v[80:95]
    v_max3_f32 v8, v64, v65, v66
    v_max3_f32 v8, v8, v67, v68
    v_max3_f32 v8, v8, v69, v70
    v_max3_f32 v8, v8, v71, v72
    ds_read_b128 v[36:39], v5 offset:35840
    s_waitcnt lgkmcnt(5)
    v_mfma_f32_32x32x16_bf16 v[80:95], a[120:123], v[16:19], v[80:95]
    v_max3_f32 v8, v8, v73, v74
    v_max3_f32 v8, v8, v75, v76
    v_max3_f32 v8, v8, v77, v78
    v_max_f32 v8, v8, v79
    buffer_load_dwordx4 a[60:63], v249, s[40:43], s52 offen offset:1024 sc1
    s_waitcnt vmcnt(16)
    s_barrier
    ds_read_b128 v[16:19], v5 offset:36864
    s_waitcnt lgkmcnt(5)
    v_mfma_f32_32x32x16_bf16 v[80:95], a[124:127], v[20:23], v[80:95]
    v_mov_b32 v9, v8
    s_nop 1
    v_permlane32_swap_b32 v8, v9
    s_nop 0
    v_max_f32 v8, v8, v9
    ds_write_b32 v255, v8 offset:49152
    s_waitcnt lgkmcnt(0)
    s_barrier
    ds_read_b128 v[40:43], v247 offset:49152
    ds_read_b128 v[20:23], v5 offset:37888
    v_mfma_f32_32x32x16_bf16 v[80:95], a[128:131], v[24:27], v[80:95]
    s_waitcnt lgkmcnt(1)
    v_max3_f32 v8, v40, v41, v42
    v_max_f32 v8, v8, v43
    v_pk_add_f32 v[64:65], v[64:65], v[8:9] op_sel_hi:[1,0] neg_lo:[0,1] neg_hi:[0,1]
    v_pk_add_f32 v[66:67], v[66:67], v[8:9] op_sel_hi:[1,0] neg_lo:[0,1] neg_hi:[0,1]
    v_pk_add_f32 v[68:69], v[68:69], v[8:9] op_sel_hi:[1,0] neg_lo:[0,1] neg_hi:[0,1]
    buffer_load_dwordx4 a[64:67], v249, s[40:43], s53 offen offset:1024 sc1
    ds_read_b128 v[24:27], v5 offset:38912
    v_mfma_f32_32x32x16_bf16 v[80:95], a[132:135], v[28:31], v[80:95]
    v_pk_add_f32 v[70:71], v[70:71], v[8:9] op_sel_hi:[1,0] neg_lo:[0,1] neg_hi:[0,1]
    v_pk_add_f32 v[72:73], v[72:73], v[8:9] op_sel_hi:[1,0] neg_lo:[0,1] neg_hi:[0,1]
    v_pk_add_f32 v[74:75], v[74:75], v[8:9] op_sel_hi:[1,0] neg_lo:[0,1] neg_hi:[0,1]
    v_pk_add_f32 v[76:77], v[76:77], v[8:9] op_sel_hi:[1,0] neg_lo:[0,1] neg_hi:[0,1]
    ds_read_b128 v[28:31], v5 offset:39936
    v_mfma_f32_32x32x16_bf16 v[80:95], a[136:139], v[32:35], v[80:95]
    v_pk_add_f32 v[78:79], v[78:79], v[8:9] op_sel_hi:[1,0] neg_lo:[0,1] neg_hi:[0,1]
    v_exp_f32 v64, v64
    v_exp_f32 v65, v65
    v_exp_f32 v66, v66
    buffer_load_dwordx4 a[68:71], v249, s[40:43], s54 offen offset:1024 sc1
    ds_read_b128 v[32:35], v5 offset:40960
    v_mfma_f32_32x32x16_bf16 v[80:95], a[140:143], v[36:39], v[80:95]
    v_exp_f32 v67, v67
    v_exp_f32 v68, v68
    v_exp_f32 v69, v69
    v_exp_f32 v70, v70
    ds_read_b128 v[36:39], v5 offset:41984
    v_mfma_f32_32x32x16_bf16 v[80:95], a[144:147], v[16:19], v[80:95]
    v_exp_f32 v71, v71
    v_exp_f32 v72, v72
    v_exp_f32 v73, v73
    v_exp_f32 v74, v74
    buffer_load_dwordx4 a[72:75], v249, s[40:43], s52 offen offset:2048 sc1
    ds_read_b128 v[16:19], v5 offset:43008
    s_waitcnt lgkmcnt(5)
    v_mfma_f32_32x32x16_bf16 v[80:95], a[148:151], v[20:23], v[80:95]
    v_exp_f32 v75, v75
    v_exp_f32 v76, v76
    v_exp_f32 v77, v77
    v_exp_f32 v78, v78
    ds_read_b128 v[20:23], v5 offset:44032
    s_waitcnt lgkmcnt(5)
    v_mfma_f32_32x32x16_bf16 v[80:95], a[152:155], v[24:27], v[80:95]
    v_exp_f32 v79, v79
    s_nop 0
    v_cvt_pk_bf16_f32 v44, v64, v65
    v_cvt_pk_bf16_f32 v45, v66, v67
    buffer_load_dwordx4 a[76:79], v249, s[40:43], s53 offen offset:2048 sc1
    ds_read_b128 v[24:27], v5 offset:45056
    s_waitcnt lgkmcnt(5)
    v_mfma_f32_32x32x16_bf16 v[80:95], a[156:159], v[28:31], v[80:95]
    v_cvt_pk_bf16_f32 v46, v68, v69
    v_cvt_pk_bf16_f32 v47, v70, v71
    v_cvt_pk_bf16_f32 v48, v72, v73
    v_cvt_pk_bf16_f32 v49, v74, v75
    ds_read_b128 v[28:31], v5 offset:46080
    s_waitcnt lgkmcnt(5)
    v_mfma_f32_32x32x16_bf16 v[80:95], a[160:163], v[32:35], v[80:95]
    v_cvt_pk_bf16_f32 v50, v76, v77
    v_cvt_pk_bf16_f32 v51, v78, v79
    buffer_store_dwordx4 v[44:47], v5, s[40:43], s14 offen offset:0 sc1
    buffer_store_dwordx4 v[48:51], v5, s[40:43], s14 offen offset:1024 sc1
    buffer_load_dwordx4 a[80:83], v249, s[40:43], s54 offen offset:2048 sc1
    ds_read_b128 v[32:35], v5 offset:47104
    s_waitcnt lgkmcnt(5)
    v_mfma_f32_32x32x16_bf16 v[80:95], a[164:167], v[36:39], v[80:95]
    v_pk_add_f32 v[64:65], v[64:65], v[72:73]
    v_pk_add_f32 v[66:67], v[66:67], v[74:75]
    v_pk_add_f32 v[68:69], v[68:69], v[76:77]
    v_pk_add_f32 v[70:71], v[70:71], v[78:79]
    ds_read_b128 v[36:39], v5 offset:48128
    s_waitcnt lgkmcnt(5)
    v_mfma_f32_32x32x16_bf16 v[80:95], a[168:171], v[16:19], v[80:95]
    v_pk_add_f32 v[64:65], v[64:65], v[68:69]
    v_pk_add_f32 v[66:67], v[66:67], v[70:71]
    v_pk_add_f32 v[64:65], v[64:65], v[66:67]
    v_add_f32 v64, v64, v65
    buffer_load_dwordx4 a[84:87], v249, s[40:43], s52 offen offset:3072 sc1
    s_waitcnt lgkmcnt(4)
    v_mfma_f32_32x32x16_bf16 v[80:95], a[172:175], v[20:23], v[80:95]
    s_waitcnt lgkmcnt(3)
    v_mfma_f32_32x32x16_bf16 v[80:95], a[176:179], v[24:27], v[80:95]
    buffer_load_dwordx4 a[88:91], v249, s[40:43], s53 offen offset:3072 sc1
    s_waitcnt lgkmcnt(2)
    v_mfma_f32_32x32x16_bf16 v[80:95], a[180:183], v[28:31], v[80:95]
    s_waitcnt lgkmcnt(1)
    v_mfma_f32_32x32x16_bf16 v[80:95], a[184:187], v[32:35], v[80:95]
    buffer_load_dwordx4 a[92:95], v249, s[40:43], s54 offen offset:3072 sc1
    s_waitcnt lgkmcnt(0)
    v_mfma_f32_32x32x16_bf16 v[80:95], a[188:191], v[36:39], v[80:95]
    v_cmp_eq_u32 vcc, 1, v4
    s_nop 10
    v_max3_f32 v10, v80, v81, v82
    v_max3_f32 v10, v10, v83, v84
    v_max3_f32 v10, v10, v85, v86
    v_max3_f32 v10, v10, v87, v88
    v_max3_f32 v10, v10, v89, v90
    v_max3_f32 v10, v10, v91, v92
    v_max3_f32 v10, v10, v93, v94
    v_max_f32 v10, v10, v95
    v_mov_b32 v11, v10
    s_nop 1
    v_permlane32_swap_b32 v10, v11
    s_nop 0
    v_max_f32 v10, v10, v11
    ds_write_b32 v255, v10 offset:49664
    s_waitcnt lgkmcnt(0)
    s_barrier
    ds_read_b128 v[40:43], v247 offset:49664
    s_waitcnt lgkmcnt(0)
    v_max3_f32 v10, v40, v41, v42
    v_max_f32 v10, v10, v43
    v_pk_add_f32 v[80:81], v[80:81], v[10:11] op_sel_hi:[1,0] neg_lo:[0,1] neg_hi:[0,1]
    v_pk_add_f32 v[82:83], v[82:83], v[10:11] op_sel_hi:[1,0] neg_lo:[0,1] neg_hi:[0,1]
    v_pk_add_f32 v[84:85], v[84:85], v[10:11] op_sel_hi:[1,0] neg_lo:[0,1] neg_hi:[0,1]
    v_pk_add_f32 v[86:87], v[86:87], v[10:11] op_sel_hi:[1,0] neg_lo:[0,1] neg_hi:[0,1]
    v_pk_add_f32 v[88:89], v[88:89], v[10:11] op_sel_hi:[1,0] neg_lo:[0,1] neg_hi:[0,1]
    v_pk_add_f32 v[90:91], v[90:91], v[10:11] op_sel_hi:[1,0] neg_lo:[0,1] neg_hi:[0,1]
    v_pk_add_f32 v[92:93], v[92:93], v[10:11] op_sel_hi:[1,0] neg_lo:[0,1] neg_hi:[0,1]
    v_pk_add_f32 v[94:95], v[94:95], v[10:11] op_sel_hi:[1,0] neg_lo:[0,1] neg_hi:[0,1]
    v_exp_f32 v80, v80
    v_exp_f32 v81, v81
    v_exp_f32 v82, v82
    v_exp_f32 v83, v83
    v_exp_f32 v84, v84
    v_exp_f32 v85, v85
    v_exp_f32 v86, v86
    v_exp_f32 v87, v87
    v_exp_f32 v88, v88
    v_exp_f32 v89, v89
    v_exp_f32 v90, v90
    v_exp_f32 v91, v91
    v_exp_f32 v92, v92
    v_exp_f32 v93, v93
    v_exp_f32 v94, v94
    v_exp_f32 v95, v95
    s_nop 0
    v_cvt_pk_bf16_f32 v52, v80, v81
    v_cvt_pk_bf16_f32 v53, v82, v83
    v_cvt_pk_bf16_f32 v54, v84, v85
    v_cvt_pk_bf16_f32 v55, v86, v87
    v_cvt_pk_bf16_f32 v56, v88, v89
    v_cvt_pk_bf16_f32 v57, v90, v91
    v_cvt_pk_bf16_f32 v58, v92, v93
    v_cvt_pk_bf16_f32 v59, v94, v95
    buffer_store_dwordx4 v[52:55], v5, s[40:43], s15 offen offset:0 sc1
    buffer_store_dwordx4 v[56:59], v5, s[40:43], s15 offen offset:1024 sc1
    v_pk_add_f32 v[80:81], v[80:81], v[88:89]
    v_pk_add_f32 v[82:83], v[82:83], v[90:91]
    v_pk_add_f32 v[84:85], v[84:85], v[92:93]
    v_pk_add_f32 v[86:87], v[86:87], v[94:95]
    v_pk_add_f32 v[80:81], v[80:81], v[84:85]
    v_pk_add_f32 v[82:83], v[82:83], v[86:87]
    v_pk_add_f32 v[80:81], v[80:81], v[82:83]
    v_add_f32 v80, v80, v81
    s_nop 1
    v_permlane32_swap_b32 v64, v80
    v_cndmask_b32 v12, v8, v10, vcc
    s_nop 0
    v_add_f32 v13, v64, v80
    buffer_store_dwordx2 v[12:13], v6, s[40:43], s8 offen sc1
    s_lshl_b32 s12, s62, 3
    s_add_u32 s12, s12, s63
    s_lshl_b32 s12, s12, 6
    s_add_u32 s12, s12, 10516608
    s_lshr_b32 s13, s64, 1
    s_lshl_b32 s13, s13, 9
    s_add_u32 s13, s13, 10516608
    v_and_b32 v10, 7, v1
    v_lshlrev_b32 v10, 6, v10
    v_add_u32 v10, s13, v10
    s_waitcnt vmcnt(0)
    s_barrier
    s_cmp_lg_u32 s3, 0
    s_cbranch_scc1 F3_NOFLAG
    v_mov_b32 v14, s68
    v_mov_b32 v15, s69
    v_mov_b32 v16, 0
    s_mov_b64 exec, 1
    buffer_store_dwordx2 v[14:15], v16, s[40:43], s12 offen sc0 sc1
    s_mov_b64 exec, -1
F3_NOFLAG:
    buffer_load_dwordx4 a[96:99], v250, s[40:43], s52 offen offset:0 sc1
    buffer_load_dwordx4 a[100:103], v250, s[40:43], s53 offen offset:0 sc1
    buffer_load_dwordx4 a[104:107], v250, s[40:43], s54 offen offset:0 sc1
    buffer_load_dwordx4 a[108:111], v250, s[40:43], s52 offen offset:1024 sc1
    buffer_load_dwordx4 a[112:115], v250, s[40:43], s53 offen offset:1024 sc1
    buffer_load_dwordx4 a[116:119], v250, s[40:43], s54 offen offset:1024 sc1
    buffer_load_dwordx4 a[120:123], v250, s[40:43], s52 offen offset:2048 sc1
    buffer_load_dwordx4 a[124:127], v250, s[40:43], s53 offen offset:2048 sc1
    buffer_load_dwordx4 a[128:131], v250, s[40:43], s54 offen offset:2048 sc1
    buffer_load_dwordx4 a[132:135], v250, s[40:43], s52 offen offset:3072 sc1
    buffer_load_dwordx4 a[136:139], v250, s[40:43], s53 offen offset:3072 sc1
    buffer_load_dwordx4 a[140:143], v250, s[40:43], s54 offen offset:3072 sc1
    buffer_load_dwordx4 a[144:147], v251, s[40:43], s52 offen offset:0 sc1
    buffer_load_dwordx4 a[148:151], v251, s[40:43], s53 offen offset:0 sc1
    buffer_load_dwordx4 a[152:155], v251, s[40:43], s54 offen offset:0 sc1
    buffer_load_dwordx4 a[156:159], v251, s[40:43], s52 offen offset:1024 sc1
    buffer_load_dwordx4 a[160:163], v251, s[40:43], s53 offen offset:1024 sc1
    buffer_load_dwordx4 a[164:167], v251, s[40:43], s54 offen offset:1024 sc1
    buffer_load_dwordx4 a[168:171], v251, s[40:43], s52 offen offset:2048 sc1
    buffer_load_dwordx4 a[172:175], v251, s[40:43], s53 offen offset:2048 sc1
    buffer_load_dwordx4 a[176:179], v251, s[40:43], s54 offen offset:2048 sc1
    buffer_load_dwordx4 a[180:183], v251, s[40:43], s52 offen offset:3072 sc1
    buffer_load_dwordx4 a[184:187], v251, s[40:43], s53 offen offset:3072 sc1
    buffer_load_dwordx4 a[188:191], v251, s[40:43], s54 offen offset:3072 sc1
    v_and_b32 v9, 31, v1
    v_mul_u32_u24 v11, 768, v9
    v_lshl_add_u32 v11, v4, 3, v11
    s_mul_i32 s13, s64, 24576
    s_mul_i32 s14, s65, 192
    s_add_u32 s13, s13, s14
    s_lshl_b32 s15, s3, 4
    s_add_u32 s13, s13, s15
    v_lshlrev_b32 v12, 4, v4
    s_mul_i32 s14, s6, 4608
    s_mul_i32 s15, s65, 384
    s_add_u32 s14, s14, s15
    s_lshl_b32 s15, s3, 5
    s_add_u32 s14, s14, s15
    s_add_u32 s14, s14, 3072
    buffer_load_dwordx2 v[216:217], v11, s[44:47], s13 offen offset:0
    buffer_load_dwordx4 v[224:227], v12, s[40:43], s14 offen offset:0 sc1
    buffer_load_dwordx2 v[218:219], v11, s[44:47], s13 offen offset:64
    buffer_load_dwordx4 v[228:231], v12, s[40:43], s14 offen offset:128 sc1
    buffer_load_dwordx2 v[220:221], v11, s[44:47], s13 offen offset:128
    buffer_load_dwordx4 v[232:235], v12, s[40:43], s14 offen offset:256 sc1
    s_lshl_b32 s8, s64, 16
    s_lshl_b32 s9, s3, 14
    s_add_u32 s8, s8, s9
    s_add_u32 s55, s8, 6291456
    s_lshr_b32 s8, s64, 1
    s_lshl_b32 s8, s8, 14
    s_lshl_b32 s9, s3, 12
    s_add_u32 s8, s8, s9
    s_and_b32 s9, s64, 1
    s_lshl_b32 s9, s9, 8
    s_add_u32 s8, s8, s9
    s_add_u32 s8, s8, 5767168
    v_lshlrev_b32 v13, 3, v9
    v_lshl_add_u32 v7, v4, 11, v13
    s_lshl_b32 s9, s3, 8
    v_add_u32 v6, s9, v13
    s_add_u32 s15, s3, 1
    s_and_b32 s15, s15, 3
    s_mul_i32 s15, s15, 9216
    v_add_u32 v237, s15, v5
    s_add_u32 s15, s3, 2
    s_and_b32 s15, s15, 3
    s_mul_i32 s15, s15, 9216
    v_add_u32 v238, s15, v5
    s_add_u32 s15, s3, 3
    s_and_b32 s15, s15, 3
    s_mul_i32 s15, s15, 9216
    v_add_u32 v239, s15, v5
    s_mul_i32 s15, s3, 9216
    v_add_u32 v236, s15, v5
    s_cmp_lg_u32 s3, 0
    s_cbranch_scc1 H3_SKIP
    s_mov_b32 s58, 0
H3_POLL:
    buffer_load_dwordx2 v[14:15], v10, s[40:43], 0 offen sc1
    s_add_u32 s58, s58, 1
    s_waitcnt vmcnt(0)
    v_cmp_ne_u32 vcc, s68, v14
    v_cmp_ne_u32 s[56:57], s69, v15
    s_cmp_gt_u32 s58, 100000
    s_cbranch_scc1 H3_DONE
    s_or_b64 vcc, vcc, s[56:57]
    s_cbranch_vccz H3_DONE
    s_sleep 1
    s_branch H3_POLL
H3_DONE:
H3_SKIP:
    s_barrier
    buffer_load_dwordx2 v[16:17], v7, s[40:43], s8 offen offset:0 sc1
    buffer_load_dwordx2 v[18:19], v7, s[40:43], s8 offen offset:512 sc1
    buffer_load_dwordx2 v[20:21], v7, s[40:43], s8 offen offset:1024 sc1
    buffer_load_dwordx2 v[22:23], v7, s[40:43], s8 offen offset:1536 sc1
    buffer_load_dwordx4 a[192:195], v5, s[40:43], s55 offen offset:0 sc1
    buffer_load_dwordx4 a[196:199], v5, s[40:43], s55 offen offset:1024 sc1
    buffer_load_dwordx4 a[200:203], v5, s[40:43], s55 offen offset:2048 sc1
    buffer_load_dwordx4 a[204:207], v5, s[40:43], s55 offen offset:3072 sc1
    buffer_load_dwordx4 a[208:211], v252, s[40:43], s55 offen offset:0 sc1
    buffer_load_dwordx4 a[212:215], v252, s[40:43], s55 offen offset:1024 sc1
    buffer_load_dwordx4 a[216:219], v252, s[40:43], s55 offen offset:2048 sc1
    buffer_load_dwordx4 a[220:223], v252, s[40:43], s55 offen offset:3072 sc1
    buffer_load_dwordx4 a[224:227], v253, s[40:43], s55 offen offset:0 sc1
    buffer_load_dwordx4 a[228:231], v253, s[40:43], s55 offen offset:1024 sc1
    buffer_load_dwordx4 a[232:235], v253, s[40:43], s55 offen offset:2048 sc1
    buffer_load_dwordx4 a[236:239], v253, s[40:43], s55 offen offset:3072 sc1
    buffer_load_dwordx4 a[240:243], v254, s[40:43], s55 offen offset:0 sc1
    buffer_load_dwordx4 a[244:247], v254, s[40:43], s55 offen offset:1024 sc1
    buffer_load_dwordx4 a[248:251], v254, s[40:43], s55 offen offset:2048 sc1
    buffer_load_dwordx4 a[252:255], v254, s[40:43], s55 offen offset:3072 sc1
    s_waitcnt vmcnt(16)
    v_add_f32 v25, v17, v19
    v_add_f32 v26, v21, v23
    v_mov_b32 v24, v16
    v_add_f32 v25, v25, v26
    v_mov_b32 v27, v16
    s_nop 1
    v_permlane32_swap_b32 v24, v27
    s_nop 0
    v_max_f32 v28, v24, v27
    v_sub_f32 v30, v16, v28
    v_exp_f32 v30, v30
    s_nop 0
    v_mul_f32 v25, v25, v30
    v_mov_b32 v26, v25
    s_nop 1
    v_permlane32_swap_b32 v25, v26
    s_nop 0
    v_add_f32 v29, v25, v26
    ds_write_b64 v6, v[28:29] offset:0
    s_waitcnt vmcnt(14)
    v_mfma_f32_32x32x16_bf16 v[72:87], a[0:3], a[192:195], 0
    v_mfma_f32_32x32x16_bf16 v[88:103], a[4:7], a[192:195], 0
    v_mfma_f32_32x32x16_bf16 v[104:119], a[8:11], a[192:195], 0
    v_mfma_f32_32x32x16_bf16 v[72:87], a[12:15], a[196:199], v[72:87]
    v_mfma_f32_32x32x16_bf16 v[88:103], a[16:19], a[196:199], v[88:103]
    v_mfma_f32_32x32x16_bf16 v[104:119], a[20:23], a[196:199], v[104:119]
    s_waitcnt lgkmcnt(0)
    s_barrier
    ds_read_b64 v[16:17], v13 offset:0
    ds_read_b64 v[18:19], v13 offset:256
    ds_read_b64 v[20:21], v13 offset:512
    ds_read_b64 v[22:23], v13 offset:768
    s_waitcnt vmcnt(12)
    v_mfma_f32_32x32x16_bf16 v[72:87], a[24:27], a[200:203], v[72:87]
    v_mfma_f32_32x32x16_bf16 v[88:103], a[28:31], a[200:203], v[88:103]
    v_mfma_f32_32x32x16_bf16 v[104:119], a[32:35], a[200:203], v[104:119]
    v_mfma_f32_32x32x16_bf16 v[72:87], a[36:39], a[204:207], v[72:87]
    v_mfma_f32_32x32x16_bf16 v[88:103], a[40:43], a[204:207], v[88:103]
    v_mfma_f32_32x32x16_bf16 v[104:119], a[44:47], a[204:207], v[104:119]
    s_waitcnt lgkmcnt(0)
    v_max3_f32 v26, v16, v18, v20
    v_max_f32 v26, v26, v22
    v_sub_f32 v16, v16, v26
    v_sub_f32 v18, v18, v26
    v_sub_f32 v20, v20, v26
    v_sub_f32 v22, v22, v26
    v_sub_f32 v24, v24, v26
    v_sub_f32 v27, v27, v26
    v_exp_f32 v16, v16
    v_exp_f32 v18, v18
    v_exp_f32 v20, v20
    v_exp_f32 v22, v22
    v_exp_f32 v24, v24
    v_exp_f32 v27, v27
    v_mul_f32 v25, v16, v17
    v_fmac_f32 v25, v18, v19
    v_fmac_f32 v25, v20, v21
    v_fmac_f32 v25, v22, v23
    v_rcp_f32 v25, v25
    s_nop 0
    v_mul_f32 v32, v24, v25
    v_mul_f32 v34, v27, v25
    s_waitcnt vmcnt(10)
    v_mfma_f32_32x32x16_bf16 v[72:87], a[48:51], a[208:211], v[72:87]
    v_mfma_f32_32x32x16_bf16 v[88:103], a[52:55], a[208:211], v[88:103]
    v_mfma_f32_32x32x16_bf16 v[104:119], a[56:59], a[208:211], v[104:119]
    v_mfma_f32_32x32x16_bf16 v[72:87], a[60:63], a[212:215], v[72:87]
    v_mfma_f32_32x32x16_bf16 v[88:103], a[64:67], a[212:215], v[88:103]
    v_mfma_f32_32x32x16_bf16 v[104:119], a[68:71], a[212:215], v[104:119]
    s_waitcnt vmcnt(8)
    v_mfma_f32_32x32x16_bf16 v[72:87], a[72:75], a[216:219], v[72:87]
    v_mfma_f32_32x32x16_bf16 v[88:103], a[76:79], a[216:219], v[88:103]
    v_mfma_f32_32x32x16_bf16 v[104:119], a[80:83], a[216:219], v[104:119]
    v_mfma_f32_32x32x16_bf16 v[72:87], a[84:87], a[220:223], v[72:87]
    v_mfma_f32_32x32x16_bf16 v[88:103], a[88:91], a[220:223], v[88:103]
    v_mfma_f32_32x32x16_bf16 v[104:119], a[92:95], a[220:223], v[104:119]
    s_waitcnt vmcnt(6)
    v_mfma_f32_32x32x16_bf16 v[120:135], a[96:99], a[224:227], 0
    v_mfma_f32_32x32x16_bf16 v[136:151], a[100:103], a[224:227], 0
    v_mfma_f32_32x32x16_bf16 v[152:167], a[104:107], a[224:227], 0
    v_mfma_f32_32x32x16_bf16 v[120:135], a[108:111], a[228:231], v[120:135]
    v_mfma_f32_32x32x16_bf16 v[136:151], a[112:115], a[228:231], v[136:151]
    v_mfma_f32_32x32x16_bf16 v[152:167], a[116:119], a[228:231], v[152:167]
    s_waitcnt vmcnt(4)
    v_mfma_f32_32x32x16_bf16 v[120:135], a[120:123], a[232:235], v[120:135]
    v_pk_mul_f32 v[72:73], v[72:73], v[32:33] op_sel_hi:[1,0]
    v_pk_mul_f32 v[74:75], v[74:75], v[32:33] op_sel_hi:[1,0]
    v_pk_mul_f32 v[76:77], v[76:77], v[32:33] op_sel_hi:[1,0]
    v_pk_mul_f32 v[78:79], v[78:79], v[32:33] op_sel_hi:[1,0]
    v_mfma_f32_32x32x16_bf16 v[136:151], a[124:127], a[232:235], v[136:151]
    v_pk_mul_f32 v[80:81], v[80:81], v[32:33] op_sel_hi:[1,0]
    v_pk_mul_f32 v[82:83], v[82:83], v[32:33] op_sel_hi:[1,0]
    v_pk_mul_f32 v[84:85], v[84:85], v[32:33] op_sel_hi:[1,0]
    v_pk_mul_f32 v[86:87], v[86:87], v[32:33] op_sel_hi:[1,0]
    v_mfma_f32_32x32x16_bf16 v[152:167], a[128:131], a[232:235], v[152:167]
    v_pk_mul_f32 v[88:89], v[88:89], v[32:33] op_sel_hi:[1,0]
    v_pk_mul_f32 v[90:91], v[90:91], v[32:33] op_sel_hi:[1,0]
    v_pk_mul_f32 v[92:93], v[92:93], v[32:33] op_sel_hi:[1,0]
    v_pk_mul_f32 v[94:95], v[94:95], v[32:33] op_sel_hi:[1,0]
    v_mfma_f32_32x32x16_bf16 v[120:135], a[132:135], a[236:239], v[120:135]
    v_pk_mul_f32 v[96:97], v[96:97], v[32:33] op_sel_hi:[1,0]
    v_pk_mul_f32 v[98:99], v[98:99], v[32:33] op_sel_hi:[1,0]
    v_pk_mul_f32 v[100:101], v[100:101], v[32:33] op_sel_hi:[1,0]
    v_pk_mul_f32 v[102:103], v[102:103], v[32:33] op_sel_hi:[1,0]
    v_mfma_f32_32x32x16_bf16 v[136:151], a[136:139], a[236:239], v[136:151]
    v_pk_mul_f32 v[104:105], v[104:105], v[32:33] op_sel_hi:[1,0]
    v_pk_mul_f32 v[106:107], v[106:107], v[32:33] op_sel_hi:[1,0]
    v_pk_mul_f32 v[108:109], v[108:109], v[32:33] op_sel_hi:[1,0]
    v_pk_mul_f32 v[110:111], v[110:111], v[32:33] op_sel_hi:[1,0]
    v_mfma_f32_32x32x16_bf16 v[152:167], a[140:143], a[236:239], v[152:167]
    v_pk_mul_f32 v[112:113], v[112:113], v[32:33] op_sel_hi:[1,0]
    v_pk_mul_f32 v[114:115], v[114:115], v[32:33] op_sel_hi:[1,0]
    v_pk_mul_f32 v[116:117], v[116:117], v[32:33] op_sel_hi:[1,0]
    v_pk_mul_f32 v[118:119], v[118:119], v[32:33] op_sel_hi:[1,0]
    s_waitcnt vmcnt(2)
    v_mfma_f32_32x32x16_bf16 v[120:135], a[144:147], a[240:243], v[120:135]
    v_mfma_f32_32x32x16_bf16 v[136:151], a[148:151], a[240:243], v[136:151]
    v_mfma_f32_32x32x16_bf16 v[152:167], a[152:155], a[240:243], v[152:167]
    v_mfma_f32_32x32x16_bf16 v[120:135], a[156:159], a[244:247], v[120:135]
    v_mfma_f32_32x32x16_bf16 v[136:151], a[160:163], a[244:247], v[136:151]
    v_mfma_f32_32x32x16_bf16 v[152:167], a[164:167], a[244:247], v[152:167]
    s_waitcnt vmcnt(0)
    v_mfma_f32_32x32x16_bf16 v[120:135], a[168:171], a[248:251], v[120:135]
    v_mfma_f32_32x32x16_bf16 v[136:151], a[172:175], a[248:251], v[136:151]
    v_mfma_f32_32x32x16_bf16 v[152:167], a[176:179], a[248:251], v[152:167]
    v_mfma_f32_32x32x16_bf16 v[120:135], a[180:183], a[252:255], v[120:135]
    v_mfma_f32_32x32x16_bf16 v[136:151], a[184:187], a[252:255], v[136:151]
    v_mfma_f32_32x32x16_bf16 v[152:167], a[188:191], a[252:255], v[152:167]
    s_nop 9
    v_pk_fma_f32 v[76:77], v[124:125], v[34:35], v[76:77] op_sel_hi:[1,0,1]
    v_pk_fma_f32 v[78:79], v[126:127], v[34:35], v[78:79] op_sel_hi:[1,0,1]
    v_pk_fma_f32 v[80:81], v[128:129], v[34:35], v[80:81] op_sel_hi:[1,0,1]
    v_pk_fma_f32 v[82:83], v[130:131], v[34:35], v[82:83] op_sel_hi:[1,0,1]
    v_pk_fma_f32 v[84:85], v[132:133], v[34:35], v[84:85] op_sel_hi:[1,0,1]
    v_pk_fma_f32 v[86:87], v[134:135], v[34:35], v[86:87] op_sel_hi:[1,0,1]
    ds_write_b128 v237, v[76:79] offset:2048
    ds_write_b128 v238, v[80:83] offset:5120
    ds_write_b128 v239, v[84:87] offset:8192
    v_pk_fma_f32 v[92:93], v[140:141], v[34:35], v[92:93] op_sel_hi:[1,0,1]
    v_pk_fma_f32 v[94:95], v[142:143], v[34:35], v[94:95] op_sel_hi:[1,0,1]
    v_pk_fma_f32 v[96:97], v[144:145], v[34:35], v[96:97] op_sel_hi:[1,0,1]
    v_pk_fma_f32 v[98:99], v[146:147], v[34:35], v[98:99] op_sel_hi:[1,0,1]
    v_pk_fma_f32 v[100:101], v[148:149], v[34:35], v[100:101] op_sel_hi:[1,0,1]
    v_pk_fma_f32 v[102:103], v[150:151], v[34:35], v[102:103] op_sel_hi:[1,0,1]
    ds_write_b128 v237, v[92:95] offset:3072
    ds_write_b128 v238, v[96:99] offset:6144
    ds_write_b128 v239, v[100:103] offset:9216
    v_pk_fma_f32 v[108:109], v[156:157], v[34:35], v[108:109] op_sel_hi:[1,0,1]
    v_pk_fma_f32 v[110:111], v[158:159], v[34:35], v[110:111] op_sel_hi:[1,0,1]
    v_pk_fma_f32 v[112:113], v[160:161], v[34:35], v[112:113] op_sel_hi:[1,0,1]
    v_pk_fma_f32 v[114:115], v[162:163], v[34:35], v[114:115] op_sel_hi:[1,0,1]
    v_pk_fma_f32 v[116:117], v[164:165], v[34:35], v[116:117] op_sel_hi:[1,0,1]
    v_pk_fma_f32 v[118:119], v[166:167], v[34:35], v[118:119] op_sel_hi:[1,0,1]
    ds_write_b128 v237, v[108:111] offset:4096
    ds_write_b128 v238, v[112:115] offset:7168
    ds_write_b128 v239, v[116:119] offset:10240
    v_pk_fma_f32 v[72:73], v[120:121], v[34:35], v[72:73] op_sel_hi:[1,0,1]
    v_pk_fma_f32 v[74:75], v[122:123], v[34:35], v[74:75] op_sel_hi:[1,0,1]
    v_pk_fma_f32 v[88:89], v[136:137], v[34:35], v[88:89] op_sel_hi:[1,0,1]
    v_pk_fma_f32 v[90:91], v[138:139], v[34:35], v[90:91] op_sel_hi:[1,0,1]
    v_pk_fma_f32 v[104:105], v[152:153], v[34:35], v[104:105] op_sel_hi:[1,0,1]
    v_pk_fma_f32 v[106:107], v[154:155], v[34:35], v[106:107] op_sel_hi:[1,0,1]
    s_waitcnt lgkmcnt(0)
    s_barrier
    ds_read_b128 v[168:171], v236 offset:2048
    ds_read_b128 v[180:183], v236 offset:5120
    ds_read_b128 v[192:195], v236 offset:8192
    ds_read_b128 v[172:175], v236 offset:3072
    ds_read_b128 v[184:187], v236 offset:6144
    ds_read_b128 v[196:199], v236 offset:9216
    ds_read_b128 v[176:179], v236 offset:4096
    ds_read_b128 v[188:191], v236 offset:7168
    ds_read_b128 v[200:203], v236 offset:10240
    v_lshlrev_b32 v40, 16, v216
    v_and_b32 v41, 0xffff0000, v216
    v_lshlrev_b32 v42, 16, v217
    v_and_b32 v43, 0xffff0000, v217
    v_lshlrev_b32 v44, 16, v218
    v_and_b32 v45, 0xffff0000, v218
    v_lshlrev_b32 v46, 16, v219
    v_and_b32 v47, 0xffff0000, v219
    v_lshlrev_b32 v48, 16, v220
    v_and_b32 v49, 0xffff0000, v220
    v_lshlrev_b32 v50, 16, v221
    v_and_b32 v51, 0xffff0000, v221
    s_waitcnt lgkmcnt(6)
    v_pk_add_f32 v[72:73], v[72:73], v[168:169]
    v_pk_add_f32 v[180:181], v[180:181], v[192:193]
    v_pk_add_f32 v[74:75], v[74:75], v[170:171]
    v_pk_add_f32 v[182:183], v[182:183], v[194:195]
    v_pk_add_f32 v[72:73], v[72:73], v[180:181]
    v_pk_add_f32 v[74:75], v[74:75], v[182:183]
    v_pk_fma_f32 v[40:41], v[224:225], v[72:73], v[40:41]
    v_pk_fma_f32 v[42:43], v[226:227], v[74:75], v[42:43]
    v_cvt_pk_bf16_f32 v56, v40, v41
    v_cvt_pk_bf16_f32 v57, v42, v43
    buffer_store_dwordx2 v[56:57], v11, s[48:51], s13 offen offset:0
    s_waitcnt lgkmcnt(3)
    v_pk_add_f32 v[88:89], v[88:89], v[172:173]
    v_pk_add_f32 v[184:185], v[184:185], v[196:197]
    v_pk_add_f32 v[90:91], v[90:91], v[174:175]
    v_pk_add_f32 v[186:187], v[186:187], v[198:199]
    v_pk_add_f32 v[88:89], v[88:89], v[184:185]
    v_pk_add_f32 v[90:91], v[90:91], v[186:187]
    v_pk_fma_f32 v[44:45], v[228:229], v[88:89], v[44:45]
    v_pk_fma_f32 v[46:47], v[230:231], v[90:91], v[46:47]
    v_cvt_pk_bf16_f32 v58, v44, v45
    v_cvt_pk_bf16_f32 v59, v46, v47
    buffer_store_dwordx2 v[58:59], v11, s[48:51], s13 offen offset:64
    s_waitcnt lgkmcnt(0)
    v_pk_add_f32 v[104:105], v[104:105], v[176:177]
    v_pk_add_f32 v[188:189], v[188:189], v[200:201]
    v_pk_add_f32 v[106:107], v[106:107], v[178:179]
    v_pk_add_f32 v[190:191], v[190:191], v[202:203]
    v_pk_add_f32 v[104:105], v[104:105], v[188:189]
    v_pk_add_f32 v[106:107], v[106:107], v[190:191]
    v_pk_fma_f32 v[48:49], v[232:233], v[104:105], v[48:49]
    v_pk_fma_f32 v[50:51], v[234:235], v[106:107], v[50:51]
    v_cvt_pk_bf16_f32 v60, v48, v49
    v_cvt_pk_bf16_f32 v61, v50, v51
    buffer_store_dwordx2 v[60:61], v11, s[48:51], s13 offen offset:128
F_END:
    s_endpgm
F_CODE_END:
.section .rodata,"a"
.p2align 6
.amdhsa_kernel standalone__dit_adaln_block__diffusion_kernel
  .amdhsa_next_free_vgpr 512
  .amdhsa_next_free_sgpr 72
  .amdhsa_accum_offset 256
  .amdhsa_group_segment_fixed_size 0
  .amdhsa_kernarg_size 64
  .amdhsa_user_sgpr_count 2
  .amdhsa_user_sgpr_kernarg_segment_ptr 1
  .amdhsa_system_sgpr_workgroup_id_x 1
.end_amdhsa_kernel
```
